```python
import torch

def _softmax(x, axis=-1):
    return torch.softmax(x, dim=axis)
def _gelu(x):
    return torch.nn.functional.gelu(x, approximate="tanh")
def _silu(x):
    return torch.nn.functional.silu(x)
def _sigmoid(x):
    return torch.sigmoid(x)
def _layernorm(x, axis=-1, eps=1e-5):
    m = x.mean(dim=axis, keepdim=True)
    v = x.var(dim=axis, keepdim=True, unbiased=False)
    return (x - m) / torch.sqrt(v + eps)
def _scatter_add(tgt, idx, src, axis=0):
    return tgt.clone().index_add_(axis, idx, src)
def _segment_sum(src, seg, n):
    out = torch.zeros((n,) + src.shape[1:], dtype=src.dtype)
    return out.index_add_(0, seg, src)
def _pad(x, pw):
    flat = tuple(v for pair in reversed(pw) for v in pair)
    return torch.nn.functional.pad(x, flat)

kernel_name = 'sequential_preLN__ssm_conv_h3__glu_gated_glu__prompt'

def setup_inputs():

    _w = (lambda a: (lambda t: t.to(torch.bfloat16) if t.is_floating_point() else t)(torch.as_tensor(a)))
    def _A_setup():
        B, S, D = 1, 2048, 640
        ks = 4
        return {
            "q": _w((lambda *s: torch.randn(*s, dtype=torch.bfloat16) * 0.05)(B, S, D)),
            "k": _w((lambda *s: torch.randn(*s, dtype=torch.bfloat16) * 0.4)(B, S, D)),
            "v": _w((lambda *s: torch.randn(*s, dtype=torch.bfloat16) * 0.4)(B, S, D)),
            "shift_k": _w((lambda *s: torch.randn(*s, dtype=torch.bfloat16) * 0.4)(D, ks) * 0.5),
            "ssm_k": _w((lambda *s: torch.randn(*s, dtype=torch.bfloat16) * 0.4)(D, S) * (1.0 / S ** 0.5)),
            "ssm_D": _w((lambda *s: torch.randn(*s, dtype=torch.bfloat16) * 0.4)(D)),
        }
    _A_in = _A_setup()

    def _B_setup():
        B, S, D, F = 1, 2048, 640, 1728
        return {
            "x": _w((lambda *s: torch.randn(*s, dtype=torch.bfloat16) * 0.05)(B, S, D)),
            "w_gate": _w((lambda *s: torch.randn(*s, dtype=torch.bfloat16) * 0.05)(D, F)),
            "w_up": _w((lambda *s: torch.randn(*s, dtype=torch.bfloat16) * 0.05)(D, F)),
            "w_down": _w((lambda *s: torch.randn(*s, dtype=torch.bfloat16) * 0.05)(F, D)),
        }
    _B_in = _B_setup()

    return {
        "A_q": _A_in["q"],
        "A_k": _A_in["k"],
        "A_v": _A_in["v"],
        "A_shift_k": _A_in["shift_k"],
        "A_ssm_k": _A_in["ssm_k"],
        "A_ssm_D": _A_in["ssm_D"],
        "B_x": _B_in["x"],
        "B_w_gate": _B_in["w_gate"],
        "B_w_up": _B_in["w_up"],
        "B_w_down": _B_in["w_down"],
    }

def reference(A_q, A_k, A_v, A_shift_k, A_ssm_k, A_ssm_D, B_x, B_w_gate, B_w_up, B_w_down):
    def _A_ref(q, k, v, shift_k, ssm_k, ssm_D):
        B, S, D = q.shape
        ks = shift_k.shape[-1]
        k_pad = _pad(k, ((0, 0), (ks - 1, 0), (0, 0)))
        k_shift = torch.zeros_like(k)
        for t in range(ks):
            k_shift = k_shift + k_pad[:, t:t + S, :] * shift_k[:, ks - 1 - t][None, None, :]
        kv = k_shift * v
        L = 2 * S
        kv_pad = _pad(kv, ((0, 0), (0, S), (0, 0)))
        kf_pad = _pad(ssm_k, ((0, 0), (0, S)))
        kv_f = (lambda x, axes=(-2,-1): torch.fft.rfft2(x.float(), dim=axes))(kv_pad[:, None, :, :], axes=(1, 2))
        kf_f = (lambda x, axes=(-2,-1): torch.fft.rfft2(x.float(), dim=axes))(kf_pad[:, None, :], axes=(1, 2))
        kf_f = (lambda x, *d: x.permute(*d))(kf_f, 1, 2, 0)
        y_f = kv_f * kf_f[None, :, :, :]
        y = (lambda x, s, axes=(-2,-1): torch.fft.irfft2(x, s=s, dim=axes).to(torch.bfloat16))(y_f, (1, L), axes=(1, 2))[:, 0, :S, :]
        y = y + kv * ssm_D[None, None, :]
        return q * y

    def _B_ref(x, w_gate, w_up, w_down):
        g = torch.einsum("bsd,df->bsf", x, w_gate)
        u = torch.einsum("bsd,df->bsf", x, w_up)
        h = _sigmoid(g) * u
        return torch.einsum("bsf,fd->bsd", h, w_down)

    x = A_q
    h = x + _A_ref(_layernorm(x, axis=-1), A_k, A_v, A_shift_k, A_ssm_k, A_ssm_D)
    h2 = h + _B_ref(_layernorm(h, axis=-1), B_w_gate, B_w_up, B_w_down)
    return h2
```

```asm
; @launch grid=(256,1,1) block=(256,1,1) lds=163840
.amdgcn_target "amdgcn-amd-amdhsa--gfx950"
.text
.globl sequential_preLN__ssm_conv_h3__glu_gated_glu__prompt_kernel
    .p2align 8
    .type sequential_preLN__ssm_conv_h3__glu_gated_glu__prompt_kernel,@function
sequential_preLN__ssm_conv_h3__glu_gated_glu__prompt_kernel:
    s_cmp_lt_u32 s2, 160
    s_cbranch_scc1 L_conv
    s_cmp_ge_u32 s2, 256
    s_cbranch_scc1 L_exit
    s_cmp_lt_u32 s2, 240
    s_cbranch_scc1 L_side
    s_getpc_b64 s[34:35]
L_pc:
    s_and_b32 s36, s2, 8
    s_lshl_b32 s36, s36, 12
    v_lshl_add_u32 v1, v0, 7, s36
    v_min_u32 v2, L_code_end-L_pc-4, v1
    v_mov_b32 v3, s35
    v_add_co_u32 v2, vcc, s34, v2
    s_nop 1
    v_addc_co_u32 v3, vcc, 0, v3, vcc
    global_load_dword v250, v[2:3], off
    s_branch L_side
L_conv:
    s_load_dwordx2 s[12:13], s[0:1], 8
    s_load_dwordx2 s[16:17], s[0:1], 16
    s_load_dwordx2 s[20:21], s[0:1], 24
    s_mov_b32 s14, 2621440
    s_mov_b32 s15, 0x20000
    s_mov_b64 s[18:19], s[14:15]
    s_movk_i32 s22, 5120
    s_mov_b32 s23, s15
    v_lshrrev_b32 v1, 6, v0
    s_and_b32 s4, s2, 7
    v_readfirstlane_b32 s33, v1
    s_lshr_b32 s5, s2, 3
    v_and_b32 v0, 63, v0
    s_lshr_b32 s6, s4, 2
    s_add_u32 s6, s6, 8
    s_and_b32 s7, s4, 3
    s_lshl_b32 s7, s7, 2
    s_add_u32 s7, s7, s5
    s_sub_u32 s7, s7, 16
    s_add_u32 s34, s4, 7
    s_and_b32 s34, s34, 7
    s_cmp_lt_u32 s5, 16
    s_cselect_b32 s6, s34, s6
    s_cselect_b32 s7, s5, s7
    v_lshrrev_b32 v7, 4, v0
    v_and_b32 v6, 15, v0
    s_lshl_b32 s34, s7, 2
    s_add_u32 s34, s34, s33
    s_mul_i32 s34, s34, 40960
    s_lshl_b32 s35, s6, 7
    s_add_u32 s34, s34, s35
    v_mul_u32_u24 v1, 10240, v7
    v_lshl_add_u32 v1, v6, 3, v1
    v_add_u32 v1, s34, v1
    v_subrev_u32 v2, 3840, v1
    s_lshl_b32 s35, s6, 9
    v_lshlrev_b32 v3, 5, v6
    s_movk_i32 s36, 5120
    s_waitcnt lgkmcnt(0)
    buffer_load_dwordx4 v[48:51], v3, s[20:23], s35 offen
    buffer_load_dwordx4 v[52:55], v3, s[20:23], s35 offen offset:16
    buffer_load_dwordx2 v[8:9], v2, s[12:15], 0 offen offset:0
    buffer_load_dwordx2 v[10:11], v2, s[12:15], 0 offen offset:1280
    buffer_load_dwordx2 v[12:13], v2, s[12:15], 0 offen offset:2560
    buffer_load_dwordx2 v[14:15], v1, s[12:15], 0 offen offset:0
    buffer_load_dwordx2 v[16:17], v1, s[12:15], 0 offen offset:1280
    buffer_load_dwordx2 v[18:19], v1, s[12:15], 0 offen offset:2560
    buffer_load_dwordx2 v[20:21], v1, s[12:15], 0 offen offset:3840
    buffer_load_dwordx2 v[22:23], v1, s[12:15], s36 offen offset:0
    buffer_load_dwordx2 v[24:25], v1, s[12:15], s36 offen offset:1280
    buffer_load_dwordx2 v[26:27], v1, s[12:15], s36 offen offset:2560
    buffer_load_dwordx2 v[28:29], v1, s[12:15], s36 offen offset:3840
    buffer_load_dwordx2 v[30:31], v1, s[16:19], 0 offen offset:0
    buffer_load_dwordx2 v[32:33], v1, s[16:19], 0 offen offset:1280
    buffer_load_dwordx2 v[34:35], v1, s[16:19], 0 offen offset:2560
    buffer_load_dwordx2 v[36:37], v1, s[16:19], 0 offen offset:3840
    buffer_load_dwordx2 v[38:39], v1, s[16:19], s36 offen offset:0
    buffer_load_dwordx2 v[40:41], v1, s[16:19], s36 offen offset:1280
    buffer_load_dwordx2 v[42:43], v1, s[16:19], s36 offen offset:2560
    buffer_load_dwordx2 v[44:45], v1, s[16:19], s36 offen offset:3840
    s_load_dwordx2 s[24:25], s[0:1], 32
    s_mov_b32 s26, 2621440
    s_mov_b32 s27, 0x20000
    s_load_dwordx2 s[28:29], s[0:1], 40
    s_mov_b32 s30, 1280
    s_mov_b32 s31, 0x20000
    s_load_dwordx2 s[8:9], s[0:1], 96
    s_mov_b32 s10, 22937600
    s_mov_b32 s11, 0x20000
    s_load_dwordx2 s[48:49], s[0:1], 80
    s_mov_b32 s50, 2621440
    s_mov_b32 s51, 0x20000
    s_load_dwordx2 s[52:53], s[0:1], 88
    s_mov_b32 s54, 256
    s_mov_b32 s55, 0x20000
    s_mov_b32 s59, 0xffff0000
    s_lshr_b32 s34, s5, 2
    s_lshl_b32 s34, s34, 2
    s_lshr_b32 s34, 19088743, s34
    s_and_b32 s34, s34, 7
    s_and_b32 s35, s5, 3
    s_and_b32 s36, s4, 1
    s_lshr_b32 s37, s4, 1
    s_lshl_b32 s96, s34, 1
    s_add_u32 s96, s96, s36
    s_lshl_b32 s97, s37, 2
    s_add_u32 s97, s97, s35
    s_lshl_b32 s98, s96, 1
    s_and_b32 s36, s37, 1
    s_add_u32 s98, s98, s36
    s_and_b32 s99, s4, 4
    s_add_u32 s99, s99, s35
    s_mul_i32 s92, s97, 294912
    s_lshl_b32 s93, s33, 12
    s_add_u32 s92, s92, s93
    s_add_u32 s92, s92, 7929856
    s_mul_i32 s95, s99, 56
    s_mul_i32 s35, s33, 14
    s_add_u32 s95, s95, s35
    s_mul_i32 s95, s95, 5120
    s_add_u32 s95, s95, 12648448
    s_lshl_b32 s34, s6, 4
    s_add_u32 s34, s34, s7
    s_lshl_b32 s35, s34, 2
    s_add_u32 s35, s35, s33
    s_lshl_b32 s38, s35, 12
    s_lshl_b32 s39, s35, 1
    v_lshlrev_b32 v1, 4, v0
    v_mov_b32 v2, 0
    s_load_dwordx2 s[44:45], s[0:1], 72
    s_mov_b32 s46, 2211840
    s_mov_b32 s47, 0x20000
    v_add_u32 v136, 0, v0
    v_mul_u32_u24 v137, 1639, v136
    v_lshrrev_b32 v137, 16, v137
    v_mul_u32_u24 v137, 640, v137
    v_lshl_add_u32 v128, v136, 4, v137
    v_add_u32 v136, 64, v0
    v_mul_u32_u24 v137, 1639, v136
    v_lshrrev_b32 v137, 16, v137
    v_mul_u32_u24 v137, 640, v137
    v_lshl_add_u32 v129, v136, 4, v137
    v_add_u32 v136, 128, v0
    v_mul_u32_u24 v137, 1639, v136
    v_lshrrev_b32 v137, 16, v137
    v_mul_u32_u24 v137, 640, v137
    v_lshl_add_u32 v130, v136, 4, v137
    v_add_u32 v136, 192, v0
    v_mul_u32_u24 v137, 1639, v136
    v_lshrrev_b32 v137, 16, v137
    v_mul_u32_u24 v137, 640, v137
    v_lshl_add_u32 v131, v136, 4, v137
    v_add_u32 v136, 256, v0
    v_mul_u32_u24 v137, 1639, v136
    v_lshrrev_b32 v137, 16, v137
    v_mul_u32_u24 v137, 640, v137
    v_lshl_add_u32 v132, v136, 4, v137
    s_mul_i32 s100, s33, 5120
    s_addk_i32 s100, 20480
    v_lshrrev_b32 v136, 4, v0
    v_bfe_u32 v137, v0, 2, 2
    v_mul_u32_u24 v133, 160, v136
    v_mul_u32_u24 v137, 640, v137
    v_add3_u32 v133, v133, v137, s100
    v_and_b32 v137, 3, v0
    v_lshl_add_u32 v134, v137, 3, v133
    v_lshl_add_u32 v133, v137, 4, v133
    v_mul_u32_u24 v135, 286720, v136
    v_and_b32 v137, 15, v0
    v_lshl_add_u32 v135, v137, 4, v135
    s_lshl_b32 s16, s34, 2
    s_add_u32 s16, s16, s33
    s_sub_u32 s16, s16, 0
    s_mul_i32 s17, s16, 2341
    s_lshr_b32 s17, s17, 16
    s_mul_i32 s18, s17, 28
    s_sub_u32 s18, s16, s18
    s_and_b32 s19, s18, 1
    s_lshr_b32 s18, s18, 1
    s_mul_i32 s101, s17, 108
    s_lshl_b32 s20, s18, 3
    s_add_u32 s101, s101, s20
    s_lshl_b32 s101, s101, 1
    s_add_u32 s101, s101, s19
    s_mul_i32 s101, s101, 640
    s_mul_i32 s56, s19, 224
    s_lshr_b32 s20, s17, 2
    s_mul_i32 s20, s20, 14
    s_add_u32 s56, s56, s20
    s_bfe_u32 s20, s17, 0x10001
    s_add_u32 s56, s56, s20
    s_and_b32 s20, s18, 14
    s_add_u32 s20, s20, 2
    s_cmp_eq_u32 s20, 14
    s_cselect_b32 s20, 0, s20
    s_add_u32 s56, s56, s20
    s_mul_i32 s56, s56, 20
    s_and_b32 s20, s17, 1
    s_lshl_b32 s20, s20, 1
    s_add_u32 s56, s56, s20
    s_and_b32 s20, s18, 1
    s_add_u32 s56, s56, s20
    s_lshl_b32 s56, s56, 8
    s_add_u32 s56, s56, 12648448
    s_cmp_eq_u32 s18, 13
    s_cselect_b32 s58, 0, -1
    s_cmp_lt_u32 s16, 448
    s_cselect_b32 s101, s101, 0x70000000
    s_cselect_b32 s56, s56, 0x70000000
    s_add_u32 m0, s100, 0
    s_waitcnt lgkmcnt(0)
    buffer_load_dwordx4 v128, s[44:47], s101 offen lds
    s_add_u32 m0, s100, 1024
    s_nop 0
    buffer_load_dwordx4 v129, s[44:47], s101 offen lds
    s_add_u32 m0, s100, 2048
    s_nop 0
    buffer_load_dwordx4 v130, s[44:47], s101 offen lds
    s_add_u32 m0, s100, 3072
    s_nop 0
    buffer_load_dwordx4 v131, s[44:47], s101 offen lds
    s_add_u32 m0, s100, 4096
    s_nop 0
    buffer_load_dwordx4 v132, s[44:47], s101 offen lds
    s_lshl_b32 s35, s33, 6
    v_mul_u32_u24 v4, 1040, v6
    v_lshl_add_u32 v4, v7, 4, v4
    v_add_u32 v4, s35, v4
    s_mul_i32 s35, s33, 4160
    v_lshlrev_b32 v3, 4, v0
    v_add_u32 v5, s35, v3
    s_lshl_b32 s34, s6, 2
    s_add_u32 s34, s34, s33
    s_lshl_b32 s34, s34, 16
    s_lshl_b32 s35, s7, 10
    s_add_u32 s34, s34, s35
    s_mov_b32 s40, 0x05040100
    s_mov_b32 s41, 0x07060302
    s_waitcnt vmcnt(22)
    v_perm_b32 v56, v8, v10, s40
    s_waitcnt vmcnt(21)
    v_perm_b32 v57, v10, v12, s40
    s_waitcnt vmcnt(20)
    v_perm_b32 v58, v12, v14, s40
    s_waitcnt vmcnt(19)
    v_perm_b32 v59, v14, v16, s40
    s_waitcnt vmcnt(18)
    v_perm_b32 v60, v16, v18, s40
    s_waitcnt vmcnt(17)
    v_perm_b32 v61, v18, v20, s40
    s_waitcnt vmcnt(16)
    v_perm_b32 v62, v20, v22, s40
    s_waitcnt vmcnt(15)
    v_perm_b32 v63, v22, v24, s40
    s_waitcnt vmcnt(14)
    v_perm_b32 v64, v24, v26, s40
    s_waitcnt vmcnt(13)
    v_perm_b32 v65, v26, v28, s40
    v_dot2_f32_bf16 v144, v58, v48, 0
    v_dot2_f32_bf16 v145, v59, v48, 0
    v_dot2_f32_bf16 v146, v60, v48, 0
    v_dot2_f32_bf16 v147, v61, v48, 0
    v_dot2_f32_bf16 v148, v62, v48, 0
    v_dot2_f32_bf16 v149, v63, v48, 0
    v_dot2_f32_bf16 v150, v64, v48, 0
    v_dot2_f32_bf16 v151, v65, v48, 0
    v_dot2c_f32_bf16 v144, v49, v56
    v_dot2c_f32_bf16 v145, v49, v57
    v_dot2c_f32_bf16 v146, v49, v58
    v_dot2c_f32_bf16 v147, v49, v59
    v_dot2c_f32_bf16 v148, v49, v60
    v_dot2c_f32_bf16 v149, v49, v61
    v_dot2c_f32_bf16 v150, v49, v62
    v_dot2c_f32_bf16 v151, v49, v63
    v_perm_b32 v56, v8, v10, s41
    v_perm_b32 v57, v10, v12, s41
    v_perm_b32 v58, v12, v14, s41
    v_perm_b32 v59, v14, v16, s41
    v_perm_b32 v60, v16, v18, s41
    v_perm_b32 v61, v18, v20, s41
    v_perm_b32 v62, v20, v22, s41
    v_perm_b32 v63, v22, v24, s41
    v_perm_b32 v64, v24, v26, s41
    v_perm_b32 v65, v26, v28, s41
    v_dot2_f32_bf16 v152, v58, v50, 0
    v_dot2_f32_bf16 v153, v59, v50, 0
    v_dot2_f32_bf16 v154, v60, v50, 0
    v_dot2_f32_bf16 v155, v61, v50, 0
    v_dot2_f32_bf16 v156, v62, v50, 0
    v_dot2_f32_bf16 v157, v63, v50, 0
    v_dot2_f32_bf16 v158, v64, v50, 0
    v_dot2_f32_bf16 v159, v65, v50, 0
    v_dot2c_f32_bf16 v152, v51, v56
    v_dot2c_f32_bf16 v153, v51, v57
    v_dot2c_f32_bf16 v154, v51, v58
    v_dot2c_f32_bf16 v155, v51, v59
    v_dot2c_f32_bf16 v156, v51, v60
    v_dot2c_f32_bf16 v157, v51, v61
    v_dot2c_f32_bf16 v158, v51, v62
    v_dot2c_f32_bf16 v159, v51, v63
    v_perm_b32 v56, v9, v11, s40
    v_perm_b32 v57, v11, v13, s40
    v_perm_b32 v58, v13, v15, s40
    v_perm_b32 v59, v15, v17, s40
    v_perm_b32 v60, v17, v19, s40
    v_perm_b32 v61, v19, v21, s40
    v_perm_b32 v62, v21, v23, s40
    v_perm_b32 v63, v23, v25, s40
    v_perm_b32 v64, v25, v27, s40
    v_perm_b32 v65, v27, v29, s40
    v_dot2_f32_bf16 v160, v58, v52, 0
    v_dot2_f32_bf16 v161, v59, v52, 0
    v_dot2_f32_bf16 v162, v60, v52, 0
    v_dot2_f32_bf16 v163, v61, v52, 0
    v_dot2_f32_bf16 v164, v62, v52, 0
    v_dot2_f32_bf16 v165, v63, v52, 0
    v_dot2_f32_bf16 v166, v64, v52, 0
    v_dot2_f32_bf16 v167, v65, v52, 0
    v_dot2c_f32_bf16 v160, v53, v56
    v_dot2c_f32_bf16 v161, v53, v57
    v_dot2c_f32_bf16 v162, v53, v58
    v_dot2c_f32_bf16 v163, v53, v59
    v_dot2c_f32_bf16 v164, v53, v60
    v_dot2c_f32_bf16 v165, v53, v61
    v_dot2c_f32_bf16 v166, v53, v62
    v_dot2c_f32_bf16 v167, v53, v63
    v_perm_b32 v56, v9, v11, s41
    v_perm_b32 v57, v11, v13, s41
    v_perm_b32 v58, v13, v15, s41
    v_perm_b32 v59, v15, v17, s41
    v_perm_b32 v60, v17, v19, s41
    v_perm_b32 v61, v19, v21, s41
    v_perm_b32 v62, v21, v23, s41
    v_perm_b32 v63, v23, v25, s41
    v_perm_b32 v64, v25, v27, s41
    v_perm_b32 v65, v27, v29, s41
    v_dot2_f32_bf16 v168, v58, v54, 0
    v_dot2_f32_bf16 v169, v59, v54, 0
    v_dot2_f32_bf16 v170, v60, v54, 0
    v_dot2_f32_bf16 v171, v61, v54, 0
    v_dot2_f32_bf16 v172, v62, v54, 0
    v_dot2_f32_bf16 v173, v63, v54, 0
    v_dot2_f32_bf16 v174, v64, v54, 0
    v_dot2_f32_bf16 v175, v65, v54, 0
    v_dot2c_f32_bf16 v168, v55, v56
    v_dot2c_f32_bf16 v169, v55, v57
    v_dot2c_f32_bf16 v170, v55, v58
    v_dot2c_f32_bf16 v171, v55, v59
    v_dot2c_f32_bf16 v172, v55, v60
    v_dot2c_f32_bf16 v173, v55, v61
    v_dot2c_f32_bf16 v174, v55, v62
    v_dot2c_f32_bf16 v175, v55, v63
    s_waitcnt vmcnt(12)
    v_lshlrev_b32 v74, 16, v30
    s_waitcnt vmcnt(11)
    v_lshlrev_b32 v75, 16, v32
    s_waitcnt vmcnt(10)
    v_lshlrev_b32 v76, 16, v34
    s_waitcnt vmcnt(9)
    v_lshlrev_b32 v77, 16, v36
    s_waitcnt vmcnt(8)
    v_lshlrev_b32 v78, 16, v38
    s_waitcnt vmcnt(7)
    v_lshlrev_b32 v79, 16, v40
    s_waitcnt vmcnt(6)
    v_lshlrev_b32 v80, 16, v42
    s_waitcnt vmcnt(5)
    v_lshlrev_b32 v81, 16, v44
    v_pk_mul_f32 v[144:145], v[144:145], v[74:75]
    v_pk_mul_f32 v[146:147], v[146:147], v[76:77]
    v_pk_mul_f32 v[148:149], v[148:149], v[78:79]
    v_pk_mul_f32 v[150:151], v[150:151], v[80:81]
    v_cvt_pk_bf16_f32 v84, v144, v148
    v_cvt_pk_bf16_f32 v85, v145, v149
    v_cvt_pk_bf16_f32 v86, v146, v150
    v_cvt_pk_bf16_f32 v87, v147, v151
    ds_write_b128 v4, v[84:87] offset:0
    buffer_load_ushort v116, v2, s[28:31], s39 offen
    buffer_load_dwordx4 v[100:103], v1, s[24:27], s38 offen offset:0
    v_and_b32 v74, s59, v30
    v_and_b32 v75, s59, v32
    v_and_b32 v76, s59, v34
    v_and_b32 v77, s59, v36
    v_and_b32 v78, s59, v38
    v_and_b32 v79, s59, v40
    v_and_b32 v80, s59, v42
    v_and_b32 v81, s59, v44
    v_pk_mul_f32 v[152:153], v[152:153], v[74:75]
    v_pk_mul_f32 v[154:155], v[154:155], v[76:77]
    v_pk_mul_f32 v[156:157], v[156:157], v[78:79]
    buffer_load_dwordx4 v[104:107], v1, s[24:27], s38 offen offset:1024
    v_pk_mul_f32 v[158:159], v[158:159], v[80:81]
    v_cvt_pk_bf16_f32 v88, v152, v156
    v_cvt_pk_bf16_f32 v89, v153, v157
    v_cvt_pk_bf16_f32 v90, v154, v158
    v_cvt_pk_bf16_f32 v91, v155, v159
    ds_write_b128 v4, v[88:91] offset:256
    v_lshlrev_b32 v74, 16, v31
    v_lshlrev_b32 v75, 16, v33
    v_lshlrev_b32 v76, 16, v35
    v_lshlrev_b32 v77, 16, v37
    v_lshlrev_b32 v78, 16, v39
    buffer_load_dwordx4 v[108:111], v1, s[24:27], s38 offen offset:2048
    v_lshlrev_b32 v79, 16, v41
    v_lshlrev_b32 v80, 16, v43
    v_lshlrev_b32 v81, 16, v45
    v_pk_mul_f32 v[160:161], v[160:161], v[74:75]
    v_pk_mul_f32 v[162:163], v[162:163], v[76:77]
    v_pk_mul_f32 v[164:165], v[164:165], v[78:79]
    v_pk_mul_f32 v[166:167], v[166:167], v[80:81]
    v_cvt_pk_bf16_f32 v92, v160, v164
    v_cvt_pk_bf16_f32 v93, v161, v165
    v_cvt_pk_bf16_f32 v94, v162, v166
    v_cvt_pk_bf16_f32 v95, v163, v167
    buffer_load_dwordx4 v[112:115], v1, s[24:27], s38 offen offset:3072
    ds_write_b128 v4, v[92:95] offset:512
    v_and_b32 v74, s59, v31
    v_and_b32 v75, s59, v33
    v_and_b32 v76, s59, v35
    v_and_b32 v77, s59, v37
    v_and_b32 v78, s59, v39
    v_and_b32 v79, s59, v41
    v_and_b32 v80, s59, v43
    v_and_b32 v81, s59, v45
    v_pk_mul_f32 v[168:169], v[168:169], v[74:75]
    v_pk_mul_f32 v[170:171], v[170:171], v[76:77]
    v_pk_mul_f32 v[172:173], v[172:173], v[78:79]
    v_pk_mul_f32 v[174:175], v[174:175], v[80:81]
    v_cvt_pk_bf16_f32 v96, v168, v172
    v_cvt_pk_bf16_f32 v97, v169, v173
    v_cvt_pk_bf16_f32 v98, v170, v174
    v_cvt_pk_bf16_f32 v99, v171, v175
    ds_write_b128 v4, v[96:99] offset:768
    s_waitcnt lgkmcnt(0)
    s_barrier
    ds_read_b128 v[84:87], v5 offset:0
    ds_read_b128 v[88:91], v5 offset:1040
    ds_read_b128 v[92:95], v5 offset:2080
    ds_read_b128 v[96:99], v5 offset:3120
    s_waitcnt lgkmcnt(3)
    buffer_store_dwordx4 v[84:87], v3, s[8:11], s34 offen sc1
    s_addk_i32 s34, 16384
    s_waitcnt lgkmcnt(2)
    buffer_store_dwordx4 v[88:91], v3, s[8:11], s34 offen sc1
    s_addk_i32 s34, 16384
    s_waitcnt lgkmcnt(1)
    buffer_store_dwordx4 v[92:95], v3, s[8:11], s34 offen sc1
    s_addk_i32 s34, 16384
    s_waitcnt lgkmcnt(0)
    buffer_store_dwordx4 v[96:99], v3, s[8:11], s34 offen sc1
    v_and_b32 v122, 7, v0
    v_lshlrev_b32 v122, 5, v122
    buffer_load_dword v123, v122, s[52:55], 0 offen sc1
    v_mov_b32 v252, 0x80000000
    v_mov_b32 v253, 1
    v_writelane_b32 v252, 0, 0
    s_lshl_b32 s37, s6, 2
    s_add_u32 s35, s37, s33
    s_lshl_b32 s35, s35, 4
    s_add_u32 s35, s35, s7
    s_mul_i32 s35, s35, 128
    s_add_u32 s35, s35, 22282240
    s_lshr_b32 s36, s7, 2
    s_add_u32 s36, s36, s37
    s_mul_i32 s36, s36, 2048
    s_add_u32 s36, s36, 22282240
    s_waitcnt vmcnt(0)
    v_cmp_gt_u32 vcc, 1, v123
    s_nop 0
    s_cbranch_vccnz L_go_c_slow
L_go_c_ok:
    buffer_store_dword v253, v252, s[8:11], s35 offen sc1
    ds_read_b64_tr_b16 v[176:177], v133 offset:0
    ds_read_b64_tr_b16 v[178:179], v133 offset:2560
    ds_read_b64_tr_b16 v[180:181], v133 offset:8
    ds_read_b64_tr_b16 v[182:183], v133 offset:2568
    ds_read_b64_tr_b16 v[184:185], v133 offset:64
    ds_read_b64_tr_b16 v[186:187], v133 offset:2624
    ds_read_b64_tr_b16 v[188:189], v133 offset:72
    ds_read_b64_tr_b16 v[190:191], v133 offset:2632
    ds_read_b64_tr_b16 v[192:193], v134 offset:128
    ds_read_b64_tr_b16 v[194:195], v134 offset:2688
    s_waitcnt lgkmcnt(8)
    v_and_b32 v178, s58, v178
    v_and_b32 v179, s58, v179
    s_waitcnt lgkmcnt(6)
    v_and_b32 v182, s58, v182
    v_and_b32 v183, s58, v183
    s_waitcnt lgkmcnt(4)
    v_and_b32 v186, s58, v186
    v_and_b32 v187, s58, v187
    s_waitcnt lgkmcnt(2)
    v_and_b32 v190, s58, v190
    v_and_b32 v191, s58, v191
    s_waitcnt lgkmcnt(0)
    v_and_b32 v194, s58, v194
    v_and_b32 v195, s58, v195
    buffer_store_dwordx4 v[176:179], v135, s[8:11], s56 offen offset:0 sc1
    buffer_store_dwordx4 v[180:183], v135, s[8:11], s56 offen offset:1024 sc1
    buffer_store_dwordx4 v[184:187], v135, s[8:11], s56 offen offset:2048 sc1
    buffer_store_dwordx4 v[188:191], v135, s[8:11], s56 offen offset:3072 sc1
    s_addk_i32 s56, 4096
    buffer_store_dwordx4 v[192:195], v135, s[8:11], s56 offen offset:0 sc1
    s_lshl_b32 s13, s96, 2
    s_add_u32 s13, s13, s33
    s_mul_i32 s16, s13, 40960
    s_add_u32 s16, s16, 5242880
    s_mul_i32 s17, s13, 114688
    s_lshr_b32 s12, s97, 2
    s_mul_i32 s12, s12, 14336
    s_add_u32 s17, s17, s12
    s_and_b32 s12, s97, 3
    s_lshl_b32 s12, s12, 9
    s_add_u32 s17, s17, s12
    s_add_u32 s17, s17, 14942208
    s_mul_i32 s19, s13, 512
    s_add_u32 s19, s19, 22413312
    s_mul_i32 s20, s96, 2048
    s_mul_i32 s18, s97, 128
    s_add_u32 s18, s18, s20
    s_add_u32 s18, s18, 22413312
    s_add_u32 s20, s20, 22511616
    s_cmp_eq_u32 s33, 0
    s_cselect_b32 s18, s18, 0x70000000
    s_lshl_b32 s13, s98, 2
    s_add_u32 s13, s13, s33
    s_mul_i32 s28, s13, 20480
    s_mul_i32 s12, s99, 160
    s_add_u32 s28, s28, s12
    s_mul_i32 s25, s13, 57344
    s_add_u32 s25, s25, 14954496
    s_lshr_b32 s26, s13, 1
    s_mul_i32 s26, s26, 40960
    s_and_b32 s12, s33, 1
    s_lshl_b32 s12, s12, 3
    s_add_u32 s26, s26, s12
    s_mul_i32 s12, s99, 5120
    s_add_u32 s26, s26, s12
    s_add_u32 s26, s26, 5242880
    s_add_u32 s27, s26, 4096
    s_sub_u32 s29, s96, 10
    s_cmp_lt_u32 s96, 12
    s_cselect_b32 s29, 1, s29
    s_cmp_lt_u32 s96, 8
    s_cselect_b32 s29, 0, s29
    s_mul_i32 s29, s29, 20480
    s_add_u32 s29, s29, 22544384
    s_cmp_lt_u32 s96, 12
    s_cselect_b32 s14, s29, 22544384
    s_cselect_b32 s15, 1, 0
    s_mov_b32 s3, s16
    s_mul_i32 s30, s33, 10240
    s_add_u32 s31, s95, 61440
    s_mul_i32 s13, s98, 229376
    s_mul_i32 s12, s33, 14336
    s_add_u32 s13, s13, s12
    s_add_u32 s13, s13, 14942208
    s_add_u32 s12, s33, 1
    s_and_b32 s12, s12, 3
    s_mul_i32 s21, s12, 57344
    s_add_u32 s21, s21, s13
    s_add_u32 s12, s33, 2
    s_and_b32 s12, s12, 3
    s_mul_i32 s22, s12, 57344
    s_add_u32 s22, s22, s13
    s_add_u32 s12, s33, 3
    s_and_b32 s12, s12, 3
    s_mul_i32 s23, s12, 57344
    s_add_u32 s23, s23, s13
    s_add_u32 s12, s33, 4
    s_and_b32 s12, s12, 3
    s_mul_i32 s24, s12, 57344
    s_add_u32 s24, s24, s13
    s_movk_i32 s13, 4
    s_lshl_b32 s34, s6, 4
    s_add_u32 s34, s34, s7
    s_mul_i32 s37, s33, 4352
    s_and_b32 s38, s33, 1
    s_lshl_b32 s38, s38, 5
    s_add_u32 s37, s37, s38
    s_lshr_b32 s38, s33, 1
    s_lshl_b32 s38, s38, 7
    s_add_u32 s37, s37, s38
    s_add_u32 s37, s37, 96768
    s_mul_i32 s38, s33, 10368
    s_add_u32 s38, s38, 114176
    s_lshl_b32 s39, s33, 11
    s_add_u32 s39, s39, 155648
    v_lshrrev_b32 v7, 4, v0
    v_and_b32 v6, 15, v0
    v_bfe_u32 v8, v0, 2, 2
    v_and_b32 v9, 3, v0
    v_lshlrev_b32 v3, 2, v0
    v_add_u32 v10, s38, v3
    v_mov_b32 v3, 0
    v_mov_b32 v4, 0
    v_mov_b32 v5, 0
    ds_write2st64_b32 v10, v2, v2 offset0:0 offset1:5
    ds_write2st64_b32 v10, v2, v2 offset0:10 offset1:15
    v_add_u32 v11, 5248, v10
    ds_write2st64_b32 v11, v2, v2 offset0:0 offset1:5
    ds_write2st64_b32 v11, v2, v2 offset0:10 offset1:15
    v_add_u32 v12, s39, v1
    ds_write_b128 v12, v[2:5]
    s_sub_u32 s42, s37, 32
    v_add_u32 v120, s42, v1
    ds_write_b128 v120, v[2:5]
    v_add_u32 v10, 128, v10
    v_add_u32 v11, 136, v11
    v_sub_u32 v121, v9, v8
    v_lshlrev_b32 v121, 3, v121
    v_lshl_add_u32 v121, v7, 6, v121
    v_add_u32 v121, s37, v121
    v_lshlrev_b32 v14, 1, v7
    v_sub_u32 v14, v6, v14
    v_lshlrev_b32 v14, 3, v14
    v_and_b32 v13, 1, v6
    v_mul_u32_u24 v13, 5256, v13
    v_sub_u32 v14, v14, v13
    s_add_u32 s42, s38, 5312
    v_add_u32 v14, s42, v14
    v_add_u32 v13, 16, v0
    v_subrev_u32 v15, 47, v0
    v_cmp_gt_u32 vcc, 48, v0
    v_lshlrev_b32 v2, 5, v6
    v_lshl_add_u32 v2, v7, 3, v2
    v_cndmask_b32 v13, v15, v13, vcc
    v_add_u32 v15, 64, v13
    v_add_u32 v2, s37, v2
    v_writelane_b32 v13, 64, 63
    v_writelane_b32 v15, 0, 63
    v_lshlrev_b32 v13, 4, v13
    v_lshlrev_b32 v15, 4, v15
    v_add_u32 v13, s39, v13
    v_add_u32 v15, s39, v15
    v_mul_u32_u24 v3, 4352, v8
    v_and_b32 v4, 1, v8
    v_lshl_add_u32 v3, v4, 5, v3
    v_lshrrev_b32 v4, 1, v8
    v_lshl_add_u32 v3, v4, 7, v3
    v_lshl_add_u32 v3, v7, 6, v3
    v_lshl_add_u32 v3, v9, 3, v3
    s_lshl_b32 s42, s33, 8
    s_add_u32 s42, s42, 96768
    v_add_u32 v3, s42, v3
    v_lshlrev_b32 v4, 4, v6
    v_mul_u32_u24 v5, 40960, v7
    v_add_u32 v5, v5, v4
    v_lshl_add_u32 v4, v7, 10, v4
    s_lshl_b32 s43, s34, 14
    s_lshl_b32 s42, s33, 8
    s_add_u32 s43, s43, s42
    s_mul_i32 s44, s33, 163840
    s_lshl_b32 s42, s34, 8
    s_add_u32 s44, s44, s42
    s_lshl_b32 s45, s33, 10
    s_add_u32 s45, s45, 7864320
    v_lshlrev_b32 v116, 16, v116
    v_lshlrev_b32 v117, 16, v100
    v_add_f32 v116, v116, v117
    v_cvt_pk_bf16_f32 v116, v116, v116
    s_mov_b64 exec, 1
    v_bfi_b32 v100, s59, v100, v116
    s_mov_b64 exec, -1
    ds_write_b128 v120, v[100:103] offset:32
    ds_write_b128 v120, v[104:107] offset:1056
    ds_write_b128 v120, v[108:111] offset:2080
    ds_write_b128 v120, v[112:115] offset:3104
    ds_read_b64_tr_b16 v[16:17], v121 offset:32
    ds_read_b64_tr_b16 v[18:19], v121 offset:0
    ds_read_b64_tr_b16 v[20:21], v121 offset:288
    ds_read_b64_tr_b16 v[22:23], v121 offset:256
    ds_read_b64_tr_b16 v[24:25], v121 offset:544
    ds_read_b64_tr_b16 v[26:27], v121 offset:512
    ds_read_b64_tr_b16 v[28:29], v121 offset:800
    ds_read_b64_tr_b16 v[30:31], v121 offset:768
    ds_read_b64_tr_b16 v[32:33], v121 offset:1056
    ds_read_b64_tr_b16 v[34:35], v121 offset:1024
    ds_read_b64_tr_b16 v[36:37], v121 offset:1312
    ds_read_b64_tr_b16 v[38:39], v121 offset:1280
    ds_read_b64_tr_b16 v[40:41], v121 offset:1568
    ds_read_b64_tr_b16 v[42:43], v121 offset:1536
    ds_read_b64_tr_b16 v[44:45], v121 offset:1824
    ds_read_b64_tr_b16 v[46:47], v121 offset:1792
    ds_read_b64_tr_b16 v[48:49], v121 offset:2080
    ds_read_b64_tr_b16 v[50:51], v121 offset:2048
    ds_read_b64_tr_b16 v[52:53], v121 offset:2336
    ds_read_b64_tr_b16 v[54:55], v121 offset:2304
    ds_read_b64_tr_b16 v[56:57], v121 offset:2592
    ds_read_b64_tr_b16 v[58:59], v121 offset:2560
    ds_read_b64_tr_b16 v[60:61], v121 offset:2848
    ds_read_b64_tr_b16 v[62:63], v121 offset:2816
    ds_read_b64_tr_b16 v[64:65], v121 offset:3104
    ds_read_b64_tr_b16 v[66:67], v121 offset:3072
    ds_read_b64_tr_b16 v[68:69], v121 offset:3360
    ds_read_b64_tr_b16 v[70:71], v121 offset:3328
    ds_read_b64_tr_b16 v[72:73], v121 offset:3616
    ds_read_b64_tr_b16 v[74:75], v121 offset:3584
    ds_read_b64_tr_b16 v[76:77], v121 offset:3872
    ds_read_b64_tr_b16 v[78:79], v121 offset:3840
    v_and_b32 v8, 15, v0
    v_mul_u32_u24 v8, 128, v8
    s_mul_i32 s46, s34, 128
    s_add_u32 s46, s46, 22544384
    s_add_u32 s41, s33, 2
    s_mul_i32 s41, s41, 20480
    s_add_u32 s41, s41, s46
    s_sub_u32 s40, s46, 155648
    s_cmp_ge_u32 s33, 1
    s_cselect_b32 s46, 0x70000000, s46
    s_cselect_b32 s40, 0x70000000, s40
    s_cselect_b32 s36, 0x70000000, s36
    v_and_b32 v139, 3, v0
    v_and_b32 v138, 12, v0
    v_lshl_add_u32 v138, v138, 2, v139
    v_mul_u32_u24 v138, 128, v138
    s_mul_i32 s47, s33, 512
    s_add_u32 s47, s47, 22364160
    v_min_u32 v140, 11, v0
    v_mul_u32_u24 v140, 128, v140
    s_lshr_b32 s57, s97, 1
    s_mul_i32 s57, s57, 2048
    s_add_u32 s57, s57, 22372352
    s_lshl_b32 s39, s33, 6
    v_add_u32 v142, s39, v0
    v_min_u32 v142, 159, v142
    v_mul_u32_u24 v142, 128, v142
    s_waitcnt lgkmcnt(0)
    buffer_load_dword v9, v8, s[8:11], s36 offen sc1
    s_cmp_ge_u32 s33, 1
    s_cbranch_scc1 L_s1_ok
    s_waitcnt vmcnt(0)
    v_cmp_gt_u32 vcc, 1, v9
    s_nop 0
    s_cbranch_vccnz L_s1_slow
L_s1_ok:
    s_waitcnt vmcnt(0)
    s_barrier
    buffer_load_dwordx4 v[144:147], v4, s[8:11], s43 offen sc1
    s_addk_i32 s43, 4096
    buffer_load_dwordx4 v[148:151], v4, s[8:11], s43 offen sc1
    s_addk_i32 s43, 4096
    buffer_load_dwordx4 v[152:155], v4, s[8:11], s43 offen sc1
    s_addk_i32 s43, 4096
    buffer_load_dwordx4 v[156:159], v4, s[8:11], s43 offen sc1
    buffer_load_dword v139, v138, s[8:11], s47 offen sc1
    buffer_store_dword v253, v252, s[8:11], s40 offen sc1
    s_mul_i32 s58, s33, 28
    s_add_u32 s58, s58, 0
    v_min_u32 v128, 27, v0
    v_add_u32 v128, s58, v128
    v_mul_u32_u24 v128, 128, v128
    s_mov_b32 s58, 22388736
    s_waitcnt vmcnt(5)
    ds_write2st64_b32 v10, v144, v145 offset0:0 offset1:5
    ds_write2st64_b32 v10, v146, v147 offset0:10 offset1:15
    ds_write2st64_b32 v11, v144, v145 offset0:0 offset1:5
    ds_write2st64_b32 v11, v146, v147 offset0:10 offset1:15
    ds_read_b128 a[0:3], v14 offset:0
    ds_read_b128 a[16:19], v14 offset:64
    ds_read_b128 a[4:7], v14 offset:1280
    ds_read_b128 a[20:23], v14 offset:1344
    ds_read_b128 a[8:11], v14 offset:2560
    ds_read_b128 a[24:27], v14 offset:2624
    ds_read_b128 a[12:15], v14 offset:3840
    ds_read_b128 a[28:31], v14 offset:3904
    s_waitcnt lgkmcnt(7)
    v_mfma_f32_16x16x32_bf16 v[80:83], v[20:23], a[0:3], 0
    ds_read_b128 a[32:35], v14 offset:128
    s_waitcnt lgkmcnt(7)
    v_mfma_f32_16x16x32_bf16 v[80:83], v[16:19], a[16:19], v[80:83]
    ds_read_b128 a[36:39], v14 offset:1408
    s_waitcnt lgkmcnt(7)
    v_mfma_f32_16x16x32_bf16 v[84:87], v[20:23], a[4:7], 0
    ds_read_b128 a[168:171], v14 offset:2688
    s_waitcnt lgkmcnt(7)
    v_mfma_f32_16x16x32_bf16 v[84:87], v[16:19], a[20:23], v[84:87]
    ds_read_b128 a[172:175], v14 offset:3968
    s_waitcnt lgkmcnt(7)
    v_mfma_f32_16x16x32_bf16 v[88:91], v[20:23], a[8:11], 0
    ds_read_b128 a[176:179], v14 offset:192
    s_waitcnt lgkmcnt(7)
    v_mfma_f32_16x16x32_bf16 v[88:91], v[16:19], a[24:27], v[88:91]
    ds_read_b128 a[180:183], v14 offset:1472
    s_waitcnt lgkmcnt(7)
    v_mfma_f32_16x16x32_bf16 v[92:95], v[20:23], a[12:15], 0
    ds_read_b128 a[184:187], v14 offset:2752
    s_waitcnt lgkmcnt(7)
    v_mfma_f32_16x16x32_bf16 v[92:95], v[16:19], a[28:31], v[92:95]
    ds_read_b128 a[188:191], v14 offset:4032
    v_mfma_f32_16x16x32_bf16 v[96:99], v[28:31], a[0:3], 0
    v_mfma_f32_16x16x32_bf16 v[96:99], v[24:27], a[16:19], v[96:99]
    s_waitcnt vmcnt(4)
    ds_write2st64_b32 v10, v148, v149 offset0:1 offset1:6
    v_mfma_f32_16x16x32_bf16 v[100:103], v[28:31], a[4:7], 0
    v_mfma_f32_16x16x32_bf16 v[100:103], v[24:27], a[20:23], v[100:103]
    ds_write2st64_b32 v10, v150, v151 offset0:11 offset1:16
    v_mfma_f32_16x16x32_bf16 v[104:107], v[28:31], a[8:11], 0
    v_add_f32 v93, v93, v87
    v_add_f32 v94, v94, v91
    v_mfma_f32_16x16x32_bf16 v[104:107], v[24:27], a[24:27], v[104:107]
    ds_write2st64_b32 v11, v148, v149 offset0:1 offset1:6
    v_mfma_f32_16x16x32_bf16 v[108:111], v[28:31], a[12:15], 0
    v_add_f32 v93, v93, v90
    ds_write_b128 v13, v[92:95]
    v_mfma_f32_16x16x32_bf16 v[108:111], v[24:27], a[28:31], v[108:111]
    ds_write2st64_b32 v11, v150, v151 offset0:11 offset1:16
    s_waitcnt lgkmcnt(5)
    v_mfma_f32_16x16x32_bf16 v[96:99], v[20:23], a[32:35], v[96:99]
    ds_read_b128 v[240:243], v12 offset:0
    v_add_f32 v81, v81, v84
    v_mfma_f32_16x16x32_bf16 v[96:99], v[16:19], a[176:179], v[96:99]
    ds_read_b128 a[192:195], v14 offset:256
    v_add_f32 v82, v82, v85
    v_mfma_f32_16x16x32_bf16 v[100:103], v[20:23], a[36:39], v[100:103]
    v_add_f32 v83, v83, v86
    v_add_f32 v82, v82, v88
    v_mfma_f32_16x16x32_bf16 v[100:103], v[16:19], a[180:183], v[100:103]
    ds_read_b128 a[196:199], v14 offset:1536
    v_add_f32 v83, v83, v89
    v_mfma_f32_16x16x32_bf16 v[104:107], v[20:23], a[168:171], v[104:107]
    v_add_f32 v83, v83, v92
    v_mfma_f32_16x16x32_bf16 v[104:107], v[16:19], a[184:187], v[104:107]
    ds_read_b128 a[200:203], v14 offset:2816
    v_mfma_f32_16x16x32_bf16 v[108:111], v[20:23], a[172:175], v[108:111]
    v_mfma_f32_16x16x32_bf16 v[108:111], v[16:19], a[188:191], v[108:111]
    ds_read_b128 a[204:207], v14 offset:4096
    v_mfma_f32_16x16x32_bf16 v[112:115], v[36:39], a[0:3], 0
    s_waitcnt lgkmcnt(4)
    v_add_f32 v80, v80, v241
    v_add_f32 v81, v81, v242
    v_mfma_f32_16x16x32_bf16 v[112:115], v[32:35], a[16:19], v[112:115]
    ds_read_b128 a[208:211], v14 offset:320
    v_add_f32 v82, v82, v243
    v_mfma_f32_16x16x32_bf16 v[112:115], v[28:31], a[32:35], v[112:115]
    v_cvt_pk_bf16_f32 v80, v80, v81
    v_cvt_pk_bf16_f32 v81, v82, v83
    v_mfma_f32_16x16x32_bf16 v[112:115], v[24:27], a[176:179], v[112:115]
    ds_read_b128 a[212:215], v14 offset:1600
    s_add_u32 s43, s45, 0
    v_mfma_f32_16x16x32_bf16 v[116:119], v[36:39], a[4:7], 0
    s_waitcnt vmcnt(1)
    v_cmp_gt_u32 vcc, 1, v139
    s_nop 0
    s_cbranch_vccnz L_fa_slow
L_fa_ok:
    v_mfma_f32_16x16x32_bf16 v[116:119], v[32:35], a[20:23], v[116:119]
    ds_read_b128 a[216:219], v14 offset:2880
    ds_write_b64 v2, v[80:81] offset:0
    v_mfma_f32_16x16x32_bf16 v[116:119], v[28:31], a[36:39], v[116:119]
    buffer_load_dwordx4 v[224:227], v1, s[8:11], s43 offen sc1
    v_mfma_f32_16x16x32_bf16 v[116:119], v[24:27], a[180:183], v[116:119]
    ds_read_b128 a[220:223], v14 offset:4160
    s_add_u32 s43, s44, 2621440
    v_mfma_f32_16x16x32_bf16 v[120:123], v[36:39], a[8:11], 0
    buffer_load_dwordx4 v[208:211], v5, s[8:11], s43 offen sc1
    v_mfma_f32_16x16x32_bf16 v[120:123], v[32:35], a[24:27], v[120:123]
    ds_read_b128 a[224:227], v14 offset:384
    s_add_u32 s43, s45, 4096
    v_mfma_f32_16x16x32_bf16 v[120:123], v[28:31], a[168:171], v[120:123]
    v_add_f32 v109, v109, v103
    v_add_f32 v110, v110, v107
    v_mfma_f32_16x16x32_bf16 v[120:123], v[24:27], a[184:187], v[120:123]
    ds_read_b128 a[228:231], v14 offset:1664
    v_add_f32 v109, v109, v106
    v_mfma_f32_16x16x32_bf16 v[124:127], v[36:39], a[12:15], 0
    buffer_load_dwordx4 v[228:231], v1, s[8:11], s43 offen sc1
    v_mfma_f32_16x16x32_bf16 v[124:127], v[32:35], a[28:31], v[124:127]
    ds_read_b128 a[232:235], v14 offset:2944
    s_add_u32 s43, s44, 3276800
    v_mfma_f32_16x16x32_bf16 v[124:127], v[28:31], a[172:175], v[124:127]
    ds_write_b128 v15, v[108:111]
    v_mfma_f32_16x16x32_bf16 v[124:127], v[24:27], a[188:191], v[124:127]
    ds_read_b128 a[236:239], v14 offset:4224
    s_waitcnt lgkmcnt(5)
    v_mfma_f32_16x16x32_bf16 v[112:115], v[20:23], a[192:195], v[112:115]
    buffer_load_dwordx4 v[212:215], v5, s[8:11], s43 offen sc1
    v_mfma_f32_16x16x32_bf16 v[112:115], v[16:19], a[208:211], v[112:115]
    ds_read_b128 a[240:243], v14 offset:448
    s_add_u32 s43, s45, 8192
    v_mfma_f32_16x16x32_bf16 v[116:119], v[20:23], a[196:199], v[116:119]
    ds_read_b128 v[240:243], v12 offset:1024
    v_add_f32 v97, v97, v100
    v_mfma_f32_16x16x32_bf16 v[116:119], v[16:19], a[212:215], v[116:119]
    ds_read_b128 a[244:247], v14 offset:1728
    v_add_f32 v98, v98, v101
    v_mfma_f32_16x16x32_bf16 v[120:123], v[20:23], a[200:203], v[120:123]
    buffer_load_dwordx4 v[232:235], v1, s[8:11], s43 offen sc1
    v_mfma_f32_16x16x32_bf16 v[120:123], v[16:19], a[216:219], v[120:123]
    ds_read_b128 a[248:251], v14 offset:3008
    s_add_u32 s43, s44, 3932160
    v_mfma_f32_16x16x32_bf16 v[124:127], v[20:23], a[204:207], v[124:127]
    v_add_f32 v99, v99, v102
    v_add_f32 v98, v98, v104
    v_mfma_f32_16x16x32_bf16 v[124:127], v[16:19], a[220:223], v[124:127]
    ds_read_b128 a[252:255], v14 offset:4288
    v_add_f32 v99, v99, v105
    v_mfma_f32_16x16x32_bf16 v[80:83], v[44:47], a[0:3], 0
    buffer_load_dwordx4 v[216:219], v5, s[8:11], s43 offen sc1
    v_mfma_f32_16x16x32_bf16 v[80:83], v[40:43], a[16:19], v[80:83]
    v_add_f32 v99, v99, v108
    v_mfma_f32_16x16x32_bf16 v[80:83], v[36:39], a[32:35], v[80:83]
    v_mfma_f32_16x16x32_bf16 v[80:83], v[32:35], a[176:179], v[80:83]
    ds_write2st64_b32 v10, v152, v153 offset0:2 offset1:7
    s_add_u32 s43, s45, 12288
    v_mfma_f32_16x16x32_bf16 v[80:83], v[28:31], a[192:195], v[80:83]
    buffer_load_dwordx4 v[236:239], v1, s[8:11], s43 offen sc1
    v_mfma_f32_16x16x32_bf16 v[80:83], v[24:27], a[208:211], v[80:83]
    s_waitcnt lgkmcnt(4)
    v_add_f32 v96, v96, v241
    v_add_f32 v97, v97, v242
    v_mfma_f32_16x16x32_bf16 v[84:87], v[44:47], a[4:7], 0
    v_add_f32 v98, v98, v243
    v_cvt_pk_bf16_f32 v96, v96, v97
    v_mfma_f32_16x16x32_bf16 v[84:87], v[40:43], a[20:23], v[84:87]
    ds_write2st64_b32 v10, v154, v155 offset0:12 offset1:17
    s_add_u32 s43, s44, 4587520
    v_mfma_f32_16x16x32_bf16 v[84:87], v[36:39], a[36:39], v[84:87]
    buffer_load_dwordx4 v[220:223], v5, s[8:11], s43 offen sc1
    v_mfma_f32_16x16x32_bf16 v[84:87], v[32:35], a[180:183], v[84:87]
    v_cvt_pk_bf16_f32 v97, v98, v99
    ds_write_b64 v2, v[96:97] offset:512
    v_mfma_f32_16x16x32_bf16 v[84:87], v[28:31], a[196:199], v[84:87]
    v_add_f32 v125, v125, v119
    v_add_f32 v126, v126, v123
    v_mfma_f32_16x16x32_bf16 v[84:87], v[24:27], a[212:215], v[84:87]
    ds_write2st64_b32 v11, v152, v153 offset0:2 offset1:7
    v_mfma_f32_16x16x32_bf16 v[88:91], v[44:47], a[8:11], 0
    v_add_f32 v125, v125, v122
    ds_write_b128 v13, v[124:127]
    v_mfma_f32_16x16x32_bf16 v[88:91], v[40:43], a[24:27], v[88:91]
    ds_read_b128 v[240:243], v12 offset:0
    v_add_f32 v113, v113, v116
    v_mfma_f32_16x16x32_bf16 v[88:91], v[36:39], a[168:171], v[88:91]
    v_add_f32 v114, v114, v117
    v_add_f32 v115, v115, v118
    v_mfma_f32_16x16x32_bf16 v[88:91], v[32:35], a[184:187], v[88:91]
    ds_write2st64_b32 v11, v154, v155 offset0:12 offset1:17
    v_mfma_f32_16x16x32_bf16 v[88:91], v[28:31], a[200:203], v[88:91]
    v_add_f32 v114, v114, v120
    v_add_f32 v115, v115, v121
    v_mfma_f32_16x16x32_bf16 v[88:91], v[24:27], a[216:219], v[88:91]
    v_add_f32 v115, v115, v124
    v_mfma_f32_16x16x32_bf16 v[92:95], v[44:47], a[12:15], 0
    v_mfma_f32_16x16x32_bf16 v[92:95], v[40:43], a[28:31], v[92:95]
    ds_write2st64_b32 v10, v156, v157 offset0:3 offset1:8
    v_mfma_f32_16x16x32_bf16 v[92:95], v[36:39], a[172:175], v[92:95]
    v_mfma_f32_16x16x32_bf16 v[92:95], v[32:35], a[188:191], v[92:95]
    s_waitcnt lgkmcnt(2)
    v_add_f32 v112, v112, v241
    v_add_f32 v113, v113, v242
    v_mfma_f32_16x16x32_bf16 v[92:95], v[28:31], a[204:207], v[92:95]
    v_add_f32 v114, v114, v243
    v_cvt_pk_bf16_f32 v112, v112, v113
    v_mfma_f32_16x16x32_bf16 v[92:95], v[24:27], a[220:223], v[92:95]
    ds_write2st64_b32 v10, v158, v159 offset0:13 offset1:18
    v_mfma_f32_16x16x32_bf16 v[80:83], v[20:23], a[224:227], v[80:83]
    v_cvt_pk_bf16_f32 v113, v114, v115
    ds_write_b64 v2, v[112:113] offset:1024
    v_mfma_f32_16x16x32_bf16 v[80:83], v[16:19], a[240:243], v[80:83]
    v_mfma_f32_16x16x32_bf16 v[84:87], v[20:23], a[228:231], v[84:87]
    v_mfma_f32_16x16x32_bf16 v[84:87], v[16:19], a[244:247], v[84:87]
    ds_write2st64_b32 v11, v156, v157 offset0:3 offset1:8
    v_mfma_f32_16x16x32_bf16 v[88:91], v[20:23], a[232:235], v[88:91]
    v_mfma_f32_16x16x32_bf16 v[88:91], v[16:19], a[248:251], v[88:91]
    v_mfma_f32_16x16x32_bf16 v[92:95], v[20:23], a[236:239], v[92:95]
    v_mfma_f32_16x16x32_bf16 v[92:95], v[16:19], a[252:255], v[92:95]
    ds_write2st64_b32 v11, v158, v159 offset0:13 offset1:18
    v_mfma_f32_16x16x32_bf16 v[96:99], v[52:55], a[0:3], 0
    v_mfma_f32_16x16x32_bf16 v[96:99], v[48:51], a[16:19], v[96:99]
    v_mfma_f32_16x16x32_bf16 v[96:99], v[44:47], a[32:35], v[96:99]
    v_mfma_f32_16x16x32_bf16 v[96:99], v[40:43], a[176:179], v[96:99]
    s_nop 2
    v_add_f32 v93, v93, v87
    v_add_f32 v94, v94, v91
    v_mfma_f32_16x16x32_bf16 v[96:99], v[36:39], a[192:195], v[96:99]
    ds_read_b128 v[176:179], v14 offset:512
    v_add_f32 v93, v93, v90
    v_mfma_f32_16x16x32_bf16 v[96:99], v[32:35], a[208:211], v[96:99]
    ds_write_b128 v15, v[92:95]
    v_mfma_f32_16x16x32_bf16 v[96:99], v[28:31], a[224:227], v[96:99]
    ds_read_b128 v[180:183], v14 offset:576
    ds_read_b128 v[240:243], v12 offset:1024
    v_mfma_f32_16x16x32_bf16 v[96:99], v[24:27], a[240:243], v[96:99]
    v_add_f32 v81, v81, v84
    v_add_f32 v82, v82, v85
    v_mfma_f32_16x16x32_bf16 v[100:103], v[52:55], a[4:7], 0
    ds_read_b128 v[184:187], v14 offset:1792
    v_add_f32 v83, v83, v86
    v_mfma_f32_16x16x32_bf16 v[100:103], v[48:51], a[20:23], v[100:103]
    v_add_f32 v82, v82, v88
    v_add_f32 v83, v83, v89
    v_mfma_f32_16x16x32_bf16 v[100:103], v[44:47], a[36:39], v[100:103]
    ds_read_b128 v[188:191], v14 offset:1856
    v_add_f32 v83, v83, v92
    v_mfma_f32_16x16x32_bf16 v[100:103], v[40:43], a[180:183], v[100:103]
    v_mfma_f32_16x16x32_bf16 v[100:103], v[36:39], a[196:199], v[100:103]
    ds_read_b128 v[192:195], v14 offset:3072
    v_mfma_f32_16x16x32_bf16 v[100:103], v[32:35], a[212:215], v[100:103]
    v_mfma_f32_16x16x32_bf16 v[100:103], v[28:31], a[228:231], v[100:103]
    ds_read_b128 v[196:199], v14 offset:3136
    s_waitcnt lgkmcnt(4)
    v_add_f32 v80, v80, v241
    v_mfma_f32_16x16x32_bf16 v[100:103], v[24:27], a[244:247], v[100:103]
    v_add_f32 v81, v81, v242
    v_add_f32 v82, v82, v243
    v_mfma_f32_16x16x32_bf16 v[104:107], v[52:55], a[8:11], 0
    ds_read_b128 v[200:203], v14 offset:4352
    v_cvt_pk_bf16_f32 v80, v80, v81
    v_mfma_f32_16x16x32_bf16 v[104:107], v[48:51], a[24:27], v[104:107]
    v_cvt_pk_bf16_f32 v81, v82, v83
    ds_write_b64 v2, v[80:81] offset:1536
    v_mfma_f32_16x16x32_bf16 v[104:107], v[44:47], a[168:171], v[104:107]
    ds_read_b128 v[204:207], v14 offset:4416
    s_waitcnt vmcnt(6)
    v_lshlrev_b32 v160, 16, v208
    v_mfma_f32_16x16x32_bf16 v[104:107], v[40:43], a[184:187], v[104:107]
    v_and_b32 v161, s59, v208
    v_fma_f32 v162, v160, v224, v225
    v_mfma_f32_16x16x32_bf16 v[104:107], v[36:39], a[200:203], v[104:107]
    v_fma_f32 v163, v161, v224, v225
    v_lshlrev_b32 v164, 16, v209
    v_and_b32 v165, s59, v209
    v_mfma_f32_16x16x32_bf16 v[104:107], v[32:35], a[216:219], v[104:107]
    v_fma_f32 v166, v164, v224, v225
    v_fma_f32 v167, v165, v224, v225
    v_mfma_f32_16x16x32_bf16 v[104:107], v[28:31], a[232:235], v[104:107]
    v_lshlrev_b32 v168, 16, v210
    v_and_b32 v169, s59, v210
    v_mfma_f32_16x16x32_bf16 v[104:107], v[24:27], a[248:251], v[104:107]
    v_fma_f32 v170, v168, v226, v227
    v_fma_f32 v171, v169, v226, v227
    v_mfma_f32_16x16x32_bf16 v[108:111], v[52:55], a[12:15], 0
    v_lshlrev_b32 v172, 16, v211
    v_and_b32 v173, s59, v211
    v_mfma_f32_16x16x32_bf16 v[108:111], v[48:51], a[28:31], v[108:111]
    v_fma_f32 v174, v172, v226, v227
    v_fma_f32 v175, v173, v226, v227
    v_mfma_f32_16x16x32_bf16 v[108:111], v[44:47], a[172:175], v[108:111]
    s_waitcnt lgkmcnt(1)
    s_barrier
    v_mfma_f32_16x16x32_bf16 v[108:111], v[40:43], a[188:191], v[108:111]
    ds_read_b64_tr_b16 v[244:245], v3 offset:0
    ds_read_b64_tr_b16 v[246:247], v3 offset:32
    v_mfma_f32_16x16x32_bf16 v[108:111], v[36:39], a[204:207], v[108:111]
    ds_read_b64_tr_b16 v[132:133], v3 offset:1024
    ds_read_b64_tr_b16 v[134:135], v3 offset:1056
    s_waitcnt vmcnt(4)
    v_lshlrev_b32 v144, 16, v212
    v_mfma_f32_16x16x32_bf16 v[108:111], v[32:35], a[220:223], v[108:111]
    v_and_b32 v145, s59, v212
    v_fma_f32 v146, v144, v228, v229
    v_mfma_f32_16x16x32_bf16 v[108:111], v[28:31], a[236:239], v[108:111]
    v_fma_f32 v147, v145, v228, v229
    v_lshlrev_b32 v148, 16, v213
    v_mfma_f32_16x16x32_bf16 v[108:111], v[24:27], a[252:255], v[108:111]
    v_and_b32 v149, s59, v213
    v_mfma_f32_16x16x32_bf16 v[96:99], v[20:23], v[176:179], v[96:99]
    v_fma_f32 v150, v148, v228, v229
    v_fma_f32 v151, v149, v228, v229
    v_mfma_f32_16x16x32_bf16 v[96:99], v[16:19], v[180:183], v[96:99]
    v_lshlrev_b32 v152, 16, v214
    v_and_b32 v153, s59, v214
    v_mfma_f32_16x16x32_bf16 v[112:115], v[24:27], v[180:183], 0
    v_fma_f32 v154, v152, v230, v231
    v_fma_f32 v155, v153, v230, v231
    v_mfma_f32_16x16x32_bf16 v[112:115], v[28:31], v[176:179], v[112:115]
    v_lshlrev_b32 v156, 16, v215
    v_mfma_f32_16x16x32_bf16 v[100:103], v[20:23], v[184:187], v[100:103]
    v_and_b32 v157, s59, v215
    v_fma_f32 v158, v156, v230, v231
    v_fma_f32 v159, v157, v230, v231
    v_mfma_f32_16x16x32_bf16 v[100:103], v[16:19], v[188:191], v[100:103]
    s_add_u32 s42, s44, 5242880
    s_waitcnt lgkmcnt(3)
    v_lshlrev_b32 v248, 16, v244
    v_mfma_f32_16x16x32_bf16 v[116:119], v[24:27], v[188:191], 0
    v_and_b32 v249, s59, v244
    v_fmac_f32 v160, v162, v248
    v_mfma_f32_16x16x32_bf16 v[116:119], v[28:31], v[184:187], v[116:119]
    v_fmac_f32 v161, v163, v249
    v_mfma_f32_16x16x32_bf16 v[104:107], v[20:23], v[192:195], v[104:107]
    buffer_load_dword v129, v128, s[8:11], s58 offen sc1
    v_mfma_f32_16x16x32_bf16 v[104:107], v[16:19], v[196:199], v[104:107]
    v_cvt_pk_bf16_f32 v208, v160, v161
    v_lshlrev_b32 v248, 16, v245
    v_mfma_f32_16x16x32_bf16 v[120:123], v[24:27], v[196:199], 0
    v_and_b32 v249, s59, v245
    v_fmac_f32 v164, v166, v248
    v_mfma_f32_16x16x32_bf16 v[120:123], v[28:31], v[192:195], v[120:123]
    v_fmac_f32 v165, v167, v249
    v_mfma_f32_16x16x32_bf16 v[108:111], v[20:23], v[200:203], v[108:111]
    v_cvt_pk_bf16_f32 v209, v164, v165
    s_waitcnt lgkmcnt(2)
    v_lshlrev_b32 v248, 16, v246
    v_and_b32 v249, s59, v246
    v_mfma_f32_16x16x32_bf16 v[108:111], v[16:19], v[204:207], v[108:111]
    v_fmac_f32 v168, v170, v248
    v_fmac_f32 v169, v171, v249
    v_mfma_f32_16x16x32_bf16 v[124:127], v[24:27], v[204:207], 0
    v_cvt_pk_bf16_f32 v210, v168, v169
    v_lshlrev_b32 v248, 16, v247
    v_mfma_f32_16x16x32_bf16 v[124:127], v[28:31], v[200:203], v[124:127]
    v_and_b32 v249, s59, v247
    v_fmac_f32 v172, v174, v248
    v_mfma_f32_16x16x32_bf16 v[112:115], v[60:63], a[0:3], v[112:115]
    v_fmac_f32 v173, v175, v249
    v_cvt_pk_bf16_f32 v211, v172, v173
    v_mfma_f32_16x16x32_bf16 v[112:115], v[56:59], a[16:19], v[112:115]
    buffer_store_dwordx4 v[208:211], v5, s[8:11], s42 offen sc1
    v_mfma_f32_16x16x32_bf16 v[112:115], v[52:55], a[32:35], v[112:115]
    s_add_u32 s42, s44, 5898240
    s_waitcnt lgkmcnt(1)
    v_lshlrev_b32 v248, 16, v132
    v_mfma_f32_16x16x32_bf16 v[112:115], v[48:51], a[176:179], v[112:115]
    v_and_b32 v249, s59, v132
    v_fmac_f32 v144, v146, v248
    v_mfma_f32_16x16x32_bf16 v[112:115], v[44:47], a[192:195], v[112:115]
    ds_read_b128 v[176:179], v14 offset:640
    v_fmac_f32 v145, v147, v249
    v_cvt_pk_bf16_f32 v212, v144, v145
    v_mfma_f32_16x16x32_bf16 v[112:115], v[40:43], a[208:211], v[112:115]
    v_lshlrev_b32 v248, 16, v133
    v_and_b32 v249, s59, v133
    v_mfma_f32_16x16x32_bf16 v[112:115], v[36:39], a[224:227], v[112:115]
    ds_read_b128 v[180:183], v14 offset:704
    v_fmac_f32 v148, v150, v248
    v_mfma_f32_16x16x32_bf16 v[112:115], v[32:35], a[240:243], v[112:115]
    v_fmac_f32 v149, v151, v249
    v_cvt_pk_bf16_f32 v213, v148, v149
    v_mfma_f32_16x16x32_bf16 v[116:119], v[60:63], a[4:7], v[116:119]
    ds_read_b128 v[184:187], v14 offset:1920
    s_waitcnt lgkmcnt(3)
    v_lshlrev_b32 v248, 16, v134
    v_mfma_f32_16x16x32_bf16 v[116:119], v[56:59], a[20:23], v[116:119]
    v_and_b32 v249, s59, v134
    v_fmac_f32 v152, v154, v248
    v_mfma_f32_16x16x32_bf16 v[116:119], v[52:55], a[36:39], v[116:119]
    ds_read_b128 v[188:191], v14 offset:1984
    v_fmac_f32 v153, v155, v249
    v_mfma_f32_16x16x32_bf16 v[116:119], v[48:51], a[180:183], v[116:119]
    v_cvt_pk_bf16_f32 v214, v152, v153
    v_lshlrev_b32 v248, 16, v135
    v_mfma_f32_16x16x32_bf16 v[116:119], v[44:47], a[196:199], v[116:119]
    ds_read_b128 v[192:195], v14 offset:3200
    v_and_b32 v249, s59, v135
    v_fmac_f32 v156, v158, v248
    v_mfma_f32_16x16x32_bf16 v[116:119], v[40:43], a[212:215], v[116:119]
    v_fmac_f32 v157, v159, v249
    v_cvt_pk_bf16_f32 v215, v156, v157
    v_mfma_f32_16x16x32_bf16 v[116:119], v[36:39], a[228:231], v[116:119]
    ds_read_b128 v[196:199], v14 offset:3264
    buffer_store_dwordx4 v[212:215], v5, s[8:11], s42 offen sc1
    v_mfma_f32_16x16x32_bf16 v[116:119], v[32:35], a[244:247], v[116:119]
    v_add_f32 v109, v109, v103
    v_add_f32 v110, v110, v107
    v_mfma_f32_16x16x32_bf16 v[120:123], v[60:63], a[8:11], v[120:123]
    ds_read_b128 v[200:203], v14 offset:4480
    v_add_f32 v109, v109, v106
    v_mfma_f32_16x16x32_bf16 v[120:123], v[56:59], a[24:27], v[120:123]
    ds_write_b128 v13, v[108:111]
    v_mfma_f32_16x16x32_bf16 v[120:123], v[52:55], a[168:171], v[120:123]
    ds_read_b128 v[204:207], v14 offset:4544
    ds_read_b128 v[240:243], v12 offset:0
    v_mfma_f32_16x16x32_bf16 v[120:123], v[48:51], a[184:187], v[120:123]
    v_add_f32 v97, v97, v100
    v_add_f32 v98, v98, v101
    v_mfma_f32_16x16x32_bf16 v[120:123], v[44:47], a[200:203], v[120:123]
    v_add_f32 v99, v99, v102
    v_add_f32 v98, v98, v104
    v_add_f32 v99, v99, v105
    v_mfma_f32_16x16x32_bf16 v[120:123], v[40:43], a[216:219], v[120:123]
    v_add_f32 v99, v99, v108
    v_mfma_f32_16x16x32_bf16 v[120:123], v[36:39], a[232:235], v[120:123]
    v_mfma_f32_16x16x32_bf16 v[120:123], v[32:35], a[248:251], v[120:123]
    v_mfma_f32_16x16x32_bf16 v[124:127], v[60:63], a[12:15], v[124:127]
    v_mfma_f32_16x16x32_bf16 v[124:127], v[56:59], a[28:31], v[124:127]
    s_waitcnt lgkmcnt(0)
    v_add_f32 v96, v96, v241
    v_add_f32 v97, v97, v242
    v_mfma_f32_16x16x32_bf16 v[124:127], v[52:55], a[172:175], v[124:127]
    v_add_f32 v98, v98, v243
    v_cvt_pk_bf16_f32 v96, v96, v97
    v_mfma_f32_16x16x32_bf16 v[124:127], v[48:51], a[188:191], v[124:127]
    v_cvt_pk_bf16_f32 v97, v98, v99
    ds_write_b64 v2, v[96:97] offset:2048
    v_mfma_f32_16x16x32_bf16 v[124:127], v[44:47], a[204:207], v[124:127]
    v_mfma_f32_16x16x32_bf16 v[124:127], v[40:43], a[220:223], v[124:127]
    v_mfma_f32_16x16x32_bf16 v[124:127], v[36:39], a[236:239], v[124:127]
    v_mfma_f32_16x16x32_bf16 v[124:127], v[32:35], a[252:255], v[124:127]
    v_mfma_f32_16x16x32_bf16 v[112:115], v[20:23], v[176:179], v[112:115]
    ds_read_b128 v[176:179], v14 offset:512
    s_waitcnt vmcnt(2)
    v_cmp_gt_u32 vcc, 1, v129
    s_nop 0
    s_cbranch_vccnz L_fd_c_slow
L_fd_c_ok:
    v_mfma_f32_16x16x32_bf16 v[112:115], v[16:19], v[180:183], v[112:115]
    v_mfma_f32_16x16x32_bf16 v[116:119], v[20:23], v[184:187], v[116:119]
    ds_read_b128 v[180:183], v14 offset:576
    v_mfma_f32_16x16x32_bf16 v[116:119], v[16:19], v[188:191], v[116:119]
    v_mfma_f32_16x16x32_bf16 v[120:123], v[20:23], v[192:195], v[120:123]
    ds_read_b128 v[184:187], v14 offset:1792
    v_mfma_f32_16x16x32_bf16 v[120:123], v[16:19], v[196:199], v[120:123]
    v_mfma_f32_16x16x32_bf16 v[124:127], v[20:23], v[200:203], v[124:127]
    ds_read_b128 v[188:191], v14 offset:1856
    v_mfma_f32_16x16x32_bf16 v[124:127], v[16:19], v[204:207], v[124:127]
    s_waitcnt lgkmcnt(2)
    v_mfma_f32_16x16x32_bf16 v[144:147], v[36:39], v[176:179], 0
    ds_read_b128 v[192:195], v14 offset:3072
    v_mfma_f32_16x16x32_bf16 v[144:147], v[32:35], v[180:183], v[144:147]
    buffer_load_dwordx4 a[40:43], v1, s[8:11], s95 offen offset:0 sc1
    v_mfma_f32_16x16x32_bf16 v[80:83], v[40:43], v[180:183], 0
    ds_read_b128 v[196:199], v14 offset:3136
    v_mfma_f32_16x16x32_bf16 v[80:83], v[44:47], v[176:179], v[80:83]
    s_waitcnt lgkmcnt(2)
    v_add_f32 v125, v125, v119
    v_mfma_f32_16x16x32_bf16 v[148:151], v[36:39], v[184:187], 0
    ds_read_b128 v[200:203], v14 offset:4352
    v_add_f32 v126, v126, v123
    v_add_f32 v125, v125, v122
    v_mfma_f32_16x16x32_bf16 v[148:151], v[32:35], v[188:191], v[148:151]
    buffer_load_dwordx4 a[44:47], v1, s[8:11], s95 offen offset:1024 sc1
    v_mfma_f32_16x16x32_bf16 v[84:87], v[40:43], v[188:191], 0
    ds_read_b128 v[204:207], v14 offset:4416
    ds_write_b128 v15, v[124:127]
    v_mfma_f32_16x16x32_bf16 v[84:87], v[44:47], v[184:187], v[84:87]
    s_waitcnt lgkmcnt(3)
    ds_read_b128 v[240:243], v12 offset:1024
    v_mfma_f32_16x16x32_bf16 v[152:155], v[36:39], v[192:195], 0
    ds_read_b128 v[176:179], v14 offset:640
    v_add_f32 v113, v113, v116
    v_mfma_f32_16x16x32_bf16 v[152:155], v[32:35], v[196:199], v[152:155]
    buffer_load_dwordx4 a[48:51], v1, s[8:11], s95 offen offset:2048 sc1
    v_mfma_f32_16x16x32_bf16 v[88:91], v[40:43], v[196:199], 0
    ds_read_b128 v[180:183], v14 offset:704
    v_add_f32 v114, v114, v117
    v_mfma_f32_16x16x32_bf16 v[88:91], v[44:47], v[192:195], v[88:91]
    s_waitcnt lgkmcnt(4)
    v_add_f32 v115, v115, v118
    v_mfma_f32_16x16x32_bf16 v[156:159], v[36:39], v[200:203], 0
    ds_read_b128 v[184:187], v14 offset:1920
    v_add_f32 v114, v114, v120
    v_add_f32 v115, v115, v121
    v_mfma_f32_16x16x32_bf16 v[156:159], v[32:35], v[204:207], v[156:159]
    buffer_load_dwordx4 a[52:55], v1, s[8:11], s95 offen offset:3072 sc1
    v_mfma_f32_16x16x32_bf16 v[92:95], v[40:43], v[204:207], 0
    ds_read_b128 v[188:191], v14 offset:1984
    s_addk_i32 s95, 4096
    v_mfma_f32_16x16x32_bf16 v[92:95], v[44:47], v[200:203], v[92:95]
    s_waitcnt lgkmcnt(2)
    v_add_f32 v115, v115, v124
    v_mfma_f32_16x16x32_bf16 v[144:147], v[28:31], v[176:179], v[144:147]
    ds_read_b128 v[192:195], v14 offset:3200
    v_mfma_f32_16x16x32_bf16 v[144:147], v[24:27], v[180:183], v[144:147]
    buffer_load_dwordx4 a[56:59], v1, s[8:11], s95 offen offset:0 sc1
    v_mfma_f32_16x16x32_bf16 v[80:83], v[32:35], v[180:183], v[80:83]
    ds_read_b128 v[196:199], v14 offset:3264
    v_mfma_f32_16x16x32_bf16 v[80:83], v[36:39], v[176:179], v[80:83]
    s_waitcnt lgkmcnt(2)
    v_add_f32 v112, v112, v241
    v_mfma_f32_16x16x32_bf16 v[148:151], v[28:31], v[184:187], v[148:151]
    ds_read_b128 v[200:203], v14 offset:4480
    v_add_f32 v113, v113, v242
    v_add_f32 v114, v114, v243
    v_mfma_f32_16x16x32_bf16 v[148:151], v[24:27], v[188:191], v[148:151]
    buffer_load_dwordx4 a[60:63], v1, s[8:11], s95 offen offset:1024 sc1
    v_mfma_f32_16x16x32_bf16 v[84:87], v[32:35], v[188:191], v[84:87]
    ds_read_b128 v[204:207], v14 offset:4544
    v_cvt_pk_bf16_f32 v112, v112, v113
    v_mfma_f32_16x16x32_bf16 v[84:87], v[36:39], v[184:187], v[84:87]
    s_waitcnt lgkmcnt(2)
    v_cvt_pk_bf16_f32 v113, v114, v115
    v_mfma_f32_16x16x32_bf16 v[152:155], v[28:31], v[192:195], v[152:155]
    ds_read_b128 v[176:179], v14 offset:768
    ds_write_b64 v2, v[112:113] offset:2560
    v_mfma_f32_16x16x32_bf16 v[152:155], v[24:27], v[196:199], v[152:155]
    buffer_load_dwordx4 a[64:67], v1, s[8:11], s95 offen offset:2048 sc1
    v_mfma_f32_16x16x32_bf16 v[88:91], v[32:35], v[196:199], v[88:91]
    ds_read_b128 v[180:183], v14 offset:832
    v_lshlrev_b32 v160, 16, v216
    v_mfma_f32_16x16x32_bf16 v[88:91], v[36:39], v[192:195], v[88:91]
    s_waitcnt lgkmcnt(3)
    v_and_b32 v161, s59, v216
    v_mfma_f32_16x16x32_bf16 v[156:159], v[28:31], v[200:203], v[156:159]
    ds_read_b128 v[184:187], v14 offset:2048
    v_fma_f32 v162, v160, v232, v233
    v_fma_f32 v163, v161, v232, v233
    v_mfma_f32_16x16x32_bf16 v[156:159], v[24:27], v[204:207], v[156:159]
    buffer_load_dwordx4 a[68:71], v1, s[8:11], s95 offen offset:3072 sc1
    v_mfma_f32_16x16x32_bf16 v[92:95], v[32:35], v[204:207], v[92:95]
    ds_read_b128 v[188:191], v14 offset:2112
    s_addk_i32 s95, 4096
    v_mfma_f32_16x16x32_bf16 v[92:95], v[36:39], v[200:203], v[92:95]
    s_waitcnt lgkmcnt(2)
    v_lshlrev_b32 v164, 16, v217
    v_mfma_f32_16x16x32_bf16 v[144:147], v[20:23], v[176:179], v[144:147]
    ds_read_b128 v[192:195], v14 offset:3328
    v_and_b32 v165, s59, v217
    v_mfma_f32_16x16x32_bf16 v[144:147], v[16:19], v[180:183], v[144:147]
    buffer_load_dwordx4 a[72:75], v1, s[8:11], s95 offen offset:0 sc1
    v_mfma_f32_16x16x32_bf16 v[80:83], v[24:27], v[180:183], v[80:83]
    ds_read_b128 v[196:199], v14 offset:3392
    v_fma_f32 v166, v164, v232, v233
    v_mfma_f32_16x16x32_bf16 v[80:83], v[28:31], v[176:179], v[80:83]
    s_waitcnt lgkmcnt(2)
    v_fma_f32 v167, v165, v232, v233
    v_mfma_f32_16x16x32_bf16 v[148:151], v[20:23], v[184:187], v[148:151]
    ds_read_b128 v[200:203], v14 offset:4608
    v_lshlrev_b32 v168, 16, v218
    v_and_b32 v169, s59, v218
    v_mfma_f32_16x16x32_bf16 v[148:151], v[16:19], v[188:191], v[148:151]
    buffer_load_dwordx4 a[76:79], v1, s[8:11], s95 offen offset:1024 sc1
    v_mfma_f32_16x16x32_bf16 v[84:87], v[24:27], v[188:191], v[84:87]
    ds_read_b128 v[204:207], v14 offset:4672
    v_fma_f32 v170, v168, v234, v235
    v_mfma_f32_16x16x32_bf16 v[84:87], v[28:31], v[184:187], v[84:87]
    s_waitcnt lgkmcnt(2)
    v_fma_f32 v171, v169, v234, v235
    v_mfma_f32_16x16x32_bf16 v[152:155], v[20:23], v[192:195], v[152:155]
    buffer_load_dwordx4 a[80:83], v1, s[8:11], s95 offen offset:2048 sc1
    v_mfma_f32_16x16x32_bf16 v[152:155], v[16:19], v[196:199], v[152:155]
    v_lshlrev_b32 v172, 16, v219
    v_and_b32 v173, s59, v219
    v_mfma_f32_16x16x32_bf16 v[88:91], v[24:27], v[196:199], v[88:91]
    v_fma_f32 v174, v172, v234, v235
    v_fma_f32 v175, v173, v234, v235
    v_mfma_f32_16x16x32_bf16 v[88:91], v[28:31], v[192:195], v[88:91]
    s_waitcnt lgkmcnt(0)
    v_mfma_f32_16x16x32_bf16 v[156:159], v[20:23], v[200:203], v[156:159]
    buffer_load_dwordx4 a[84:87], v1, s[8:11], s95 offen offset:3072 sc1
    v_mfma_f32_16x16x32_bf16 v[156:159], v[16:19], v[204:207], v[156:159]
    v_mfma_f32_16x16x32_bf16 v[92:95], v[24:27], v[204:207], v[92:95]
    v_mfma_f32_16x16x32_bf16 v[92:95], v[28:31], v[200:203], v[92:95]
    s_addk_i32 s95, 4096
    s_waitcnt vmcnt(12)
    v_mfma_f32_16x16x32_bf16 v[144:147], v[68:71], a[0:3], v[144:147]
    buffer_load_dwordx4 a[88:91], v1, s[8:11], s95 offen offset:0 sc1
    v_mfma_f32_16x16x32_bf16 v[144:147], v[64:67], a[16:19], v[144:147]
    s_barrier
    ds_read_b64_tr_b16 v[244:245], v3 offset:2048
    v_mfma_f32_16x16x32_bf16 v[144:147], v[60:63], a[32:35], v[144:147]
    ds_read_b64_tr_b16 v[246:247], v3 offset:2080
    buffer_store_dword v253, v252, s[8:11], s46 offen sc1
    v_mfma_f32_16x16x32_bf16 v[144:147], v[56:59], a[176:179], v[144:147]
    v_lshlrev_b32 v96, 16, v220
    v_and_b32 v97, s59, v220
    v_mfma_f32_16x16x32_bf16 v[144:147], v[52:55], a[192:195], v[144:147]
    buffer_load_dwordx4 a[92:95], v1, s[8:11], s95 offen offset:1024 sc1
    v_fma_f32 v98, v96, v236, v237
    v_mfma_f32_16x16x32_bf16 v[144:147], v[48:51], a[208:211], v[144:147]
    v_fma_f32 v99, v97, v236, v237
    v_lshlrev_b32 v100, 16, v221
    v_mfma_f32_16x16x32_bf16 v[144:147], v[44:47], a[224:227], v[144:147]
    v_and_b32 v101, s59, v221
    v_fma_f32 v102, v100, v236, v237
    v_mfma_f32_16x16x32_bf16 v[144:147], v[40:43], a[240:243], v[144:147]
    v_fma_f32 v103, v101, v236, v237
    v_lshlrev_b32 v104, 16, v222
    v_mfma_f32_16x16x32_bf16 v[148:151], v[68:71], a[4:7], v[148:151]
    buffer_load_dwordx4 a[96:99], v1, s[8:11], s95 offen offset:2048 sc1
    v_mfma_f32_16x16x32_bf16 v[148:151], v[64:67], a[20:23], v[148:151]
    v_and_b32 v105, s59, v222
    v_fma_f32 v106, v104, v238, v239
    v_mfma_f32_16x16x32_bf16 v[148:151], v[60:63], a[36:39], v[148:151]
    v_fma_f32 v107, v105, v238, v239
    v_lshlrev_b32 v108, 16, v223
    v_mfma_f32_16x16x32_bf16 v[148:151], v[56:59], a[180:183], v[148:151]
    v_and_b32 v109, s59, v223
    v_fma_f32 v110, v108, v238, v239
    v_mfma_f32_16x16x32_bf16 v[148:151], v[52:55], a[196:199], v[148:151]
    ds_read_b128 v[176:179], v14 offset:4736
    v_fma_f32 v111, v109, v238, v239
    s_add_u32 s42, s44, 6553600
    v_mfma_f32_16x16x32_bf16 v[148:151], v[48:51], a[212:215], v[148:151]
    buffer_load_dwordx4 a[100:103], v1, s[8:11], s95 offen offset:3072 sc1
    v_mfma_f32_16x16x32_bf16 v[148:151], v[44:47], a[228:231], v[148:151]
    ds_read_b128 v[180:183], v14 offset:4800
    s_addk_i32 s95, 4096
    v_mfma_f32_16x16x32_bf16 v[148:151], v[40:43], a[244:247], v[148:151]
    s_waitcnt lgkmcnt(3)
    v_lshlrev_b32 v248, 16, v244
    v_and_b32 v249, s59, v244
    v_mfma_f32_16x16x32_bf16 v[152:155], v[68:71], a[8:11], v[152:155]
    buffer_load_dwordx4 a[104:107], v1, s[8:11], s95 offen offset:0 sc1
    v_mfma_f32_16x16x32_bf16 v[152:155], v[64:67], a[24:27], v[152:155]
    v_fmac_f32 v160, v162, v248
    v_fmac_f32 v161, v163, v249
    v_mfma_f32_16x16x32_bf16 v[152:155], v[60:63], a[168:171], v[152:155]
    v_cvt_pk_bf16_f32 v216, v160, v161
    v_lshlrev_b32 v248, 16, v245
    v_mfma_f32_16x16x32_bf16 v[152:155], v[56:59], a[184:187], v[152:155]
    v_and_b32 v249, s59, v245
    v_fmac_f32 v164, v166, v248
    v_mfma_f32_16x16x32_bf16 v[152:155], v[52:55], a[200:203], v[152:155]
    buffer_load_dwordx4 a[108:111], v1, s[8:11], s95 offen offset:1024 sc1
    v_fmac_f32 v165, v167, v249
    v_mfma_f32_16x16x32_bf16 v[152:155], v[48:51], a[216:219], v[152:155]
    v_cvt_pk_bf16_f32 v217, v164, v165
    s_waitcnt lgkmcnt(2)
    v_lshlrev_b32 v248, 16, v246
    v_mfma_f32_16x16x32_bf16 v[152:155], v[44:47], a[232:235], v[152:155]
    ds_read_b128 v[184:187], v14 offset:3456
    v_and_b32 v249, s59, v246
    v_mfma_f32_16x16x32_bf16 v[152:155], v[40:43], a[248:251], v[152:155]
    v_fmac_f32 v168, v170, v248
    v_fmac_f32 v169, v171, v249
    v_mfma_f32_16x16x32_bf16 v[156:159], v[68:71], a[12:15], v[156:159]
    ds_read_b128 v[188:191], v14 offset:3520
    v_cvt_pk_bf16_f32 v218, v168, v169
    v_mfma_f32_16x16x32_bf16 v[156:159], v[64:67], a[28:31], v[156:159]
    buffer_load_dwordx4 a[112:115], v1, s[8:11], s95 offen offset:2048 sc1
    v_mfma_f32_16x16x32_bf16 v[156:159], v[60:63], a[172:175], v[156:159]
    v_lshlrev_b32 v248, 16, v247
    v_and_b32 v249, s59, v247
    v_mfma_f32_16x16x32_bf16 v[156:159], v[56:59], a[188:191], v[156:159]
    v_fmac_f32 v172, v174, v248
    v_fmac_f32 v173, v175, v249
    v_mfma_f32_16x16x32_bf16 v[156:159], v[52:55], a[204:207], v[156:159]
    buffer_load_dwordx4 a[116:119], v1, s[8:11], s95 offen offset:3072 sc1
    v_cvt_pk_bf16_f32 v219, v172, v173
    v_mfma_f32_16x16x32_bf16 v[156:159], v[48:51], a[220:223], v[156:159]
    buffer_store_dwordx4 v[216:219], v5, s[8:11], s42 offen sc1
    v_mfma_f32_16x16x32_bf16 v[156:159], v[44:47], a[236:239], v[156:159]
    v_mfma_f32_16x16x32_bf16 v[156:159], v[40:43], a[252:255], v[156:159]
    v_mfma_f32_16x16x32_bf16 v[92:95], v[76:79], a[12:15], v[92:95]
    ds_read_b128 v[192:195], v14 offset:2176
    s_addk_i32 s95, 4096
    v_mfma_f32_16x16x32_bf16 v[92:95], v[72:75], a[28:31], v[92:95]
    buffer_load_dwordx4 a[120:123], v1, s[8:11], s95 offen offset:0 sc1
    v_mfma_f32_16x16x32_bf16 v[92:95], v[68:71], a[172:175], v[92:95]
    ds_read_b128 v[196:199], v14 offset:2240
    v_mfma_f32_16x16x32_bf16 v[92:95], v[64:67], a[188:191], v[92:95]
    v_add_f32 v157, v157, v151
    v_add_f32 v158, v158, v155
    v_mfma_f32_16x16x32_bf16 v[92:95], v[60:63], a[204:207], v[92:95]
    buffer_load_dwordx4 a[124:127], v1, s[8:11], s95 offen offset:1024 sc1
    v_add_f32 v157, v157, v154
    v_mfma_f32_16x16x32_bf16 v[92:95], v[56:59], a[220:223], v[92:95]
    ds_write_b128 v13, v[156:159]
    v_mfma_f32_16x16x32_bf16 v[92:95], v[52:55], a[236:239], v[92:95]
    ds_read_b128 v[240:243], v12 offset:0
    v_add_f32 v145, v145, v148
    v_mfma_f32_16x16x32_bf16 v[92:95], v[48:51], a[252:255], v[92:95]
    s_waitcnt lgkmcnt(6)
    v_add_f32 v146, v146, v149
    v_mfma_f32_16x16x32_bf16 v[92:95], v[20:23], v[176:179], v[92:95]
    buffer_load_dwordx4 a[128:131], v1, s[8:11], s95 offen offset:2048 sc1
    v_mfma_f32_16x16x32_bf16 v[92:95], v[16:19], v[180:183], v[92:95]
    v_add_f32 v147, v147, v150
    v_add_f32 v146, v146, v152
    v_mfma_f32_16x16x32_bf16 v[88:91], v[76:79], a[8:11], v[88:91]
    ds_read_b128 v[200:203], v14 offset:896
    v_add_f32 v147, v147, v153
    v_mfma_f32_16x16x32_bf16 v[88:91], v[72:75], a[24:27], v[88:91]
    v_add_f32 v147, v147, v156
    v_mfma_f32_16x16x32_bf16 v[88:91], v[68:71], a[168:171], v[88:91]
    ds_read_b128 v[204:207], v14 offset:960
    v_mfma_f32_16x16x32_bf16 v[88:91], v[64:67], a[184:187], v[88:91]
    buffer_load_dwordx4 a[132:135], v1, s[8:11], s95 offen offset:3072 sc1
    v_mfma_f32_16x16x32_bf16 v[88:91], v[60:63], a[200:203], v[88:91]
    v_mfma_f32_16x16x32_bf16 v[88:91], v[56:59], a[216:219], v[88:91]
    s_waitcnt lgkmcnt(2)
    v_add_f32 v144, v144, v241
    v_add_f32 v145, v145, v242
    v_mfma_f32_16x16x32_bf16 v[88:91], v[52:55], a[232:235], v[88:91]
    v_add_f32 v146, v146, v243
    v_cvt_pk_bf16_f32 v144, v144, v145
    v_mfma_f32_16x16x32_bf16 v[88:91], v[48:51], a[248:251], v[88:91]
    v_cvt_pk_bf16_f32 v145, v146, v147
    v_mfma_f32_16x16x32_bf16 v[88:91], v[20:23], v[184:187], v[88:91]
    ds_write_b64 v2, v[144:145] offset:3072
    v_mfma_f32_16x16x32_bf16 v[88:91], v[16:19], v[188:191], v[88:91]
    v_mfma_f32_16x16x32_bf16 v[84:87], v[76:79], a[4:7], v[84:87]
    v_mfma_f32_16x16x32_bf16 v[84:87], v[72:75], a[20:23], v[84:87]
    v_mfma_f32_16x16x32_bf16 v[84:87], v[68:71], a[36:39], v[84:87]
    v_mfma_f32_16x16x32_bf16 v[84:87], v[64:67], a[180:183], v[84:87]
    s_nop 3
    v_add_f32 v94, v94, v91
    v_add_f32 v93, v93, v90
    v_mfma_f32_16x16x32_bf16 v[84:87], v[60:63], a[196:199], v[84:87]
    v_add_f32 v89, v89, v92
    v_mfma_f32_16x16x32_bf16 v[84:87], v[56:59], a[212:215], v[84:87]
    v_mfma_f32_16x16x32_bf16 v[84:87], v[52:55], a[228:231], v[84:87]
    v_mfma_f32_16x16x32_bf16 v[84:87], v[48:51], a[244:247], v[84:87]
    v_mfma_f32_16x16x32_bf16 v[84:87], v[20:23], v[192:195], v[84:87]
    v_mfma_f32_16x16x32_bf16 v[84:87], v[16:19], v[196:199], v[84:87]
    v_mfma_f32_16x16x32_bf16 v[80:83], v[76:79], a[0:3], v[80:83]
    v_mfma_f32_16x16x32_bf16 v[80:83], v[72:75], a[16:19], v[80:83]
    v_mfma_f32_16x16x32_bf16 v[80:83], v[68:71], a[32:35], v[80:83]
    buffer_load_dword v141, v140, s[8:11], s57 offen sc1
    v_mfma_f32_16x16x32_bf16 v[80:83], v[64:67], a[176:179], v[80:83]
    s_nop 2
    v_add_f32 v93, v93, v87
    ds_write_b128 v15, v[92:95]
    v_mfma_f32_16x16x32_bf16 v[80:83], v[60:63], a[192:195], v[80:83]
    ds_read_b128 v[240:243], v12 offset:1024
    v_add_f32 v85, v85, v88
    v_mfma_f32_16x16x32_bf16 v[80:83], v[56:59], a[208:211], v[80:83]
    v_add_f32 v86, v86, v89
    v_mfma_f32_16x16x32_bf16 v[80:83], v[52:55], a[224:227], v[80:83]
    v_mfma_f32_16x16x32_bf16 v[80:83], v[48:51], a[240:243], v[80:83]
    s_waitcnt lgkmcnt(3)
    v_mfma_f32_16x16x32_bf16 v[80:83], v[20:23], v[200:203], v[80:83]
    v_mfma_f32_16x16x32_bf16 v[80:83], v[16:19], v[204:207], v[80:83]
    s_waitcnt lgkmcnt(0)
    v_add_f32 v242, v242, v84
    v_add_f32 v243, v243, v85
    s_nop 4
    v_add_f32 v80, v80, v241
    v_add_f32 v81, v81, v242
    v_add_f32 v82, v82, v243
    v_add_f32 v83, v83, v86
    v_cvt_pk_bf16_f32 v80, v80, v81
    v_cvt_pk_bf16_f32 v81, v82, v83
    ds_write_b64 v2, v[80:81] offset:3584
    s_waitcnt vmcnt(5) lgkmcnt(0)
    s_barrier
    ds_read_b64_tr_b16 v[244:245], v3 offset:3072
    ds_read_b64_tr_b16 v[246:247], v3 offset:3104
    s_addk_i32 s46, 20480
    buffer_store_dword v253, v252, s[8:11], s46 offen sc1
    s_add_u32 s42, s44, 7208960
    s_waitcnt lgkmcnt(1)
    v_lshlrev_b32 v248, 16, v244
    v_and_b32 v249, s59, v244
    v_pk_fma_f32 v[96:97], v[98:99], v[248:249], v[96:97]
    v_cvt_pk_bf16_f32 v220, v96, v97
    v_lshlrev_b32 v248, 16, v245
    v_and_b32 v249, s59, v245
    v_pk_fma_f32 v[100:101], v[102:103], v[248:249], v[100:101]
    v_cvt_pk_bf16_f32 v221, v100, v101
    s_waitcnt lgkmcnt(0)
    v_lshlrev_b32 v248, 16, v246
    v_and_b32 v249, s59, v246
    v_pk_fma_f32 v[104:105], v[106:107], v[248:249], v[104:105]
    v_cvt_pk_bf16_f32 v222, v104, v105
    v_lshlrev_b32 v248, 16, v247
    v_and_b32 v249, s59, v247
    v_pk_fma_f32 v[108:109], v[110:111], v[248:249], v[108:109]
    v_cvt_pk_bf16_f32 v223, v108, v109
    buffer_store_dwordx4 v[220:223], v5, s[8:11], s42 offen sc1
    s_waitcnt vmcnt(2)
    v_cmp_gt_u32 vcc, 1, v141
    s_nop 0
    s_cbranch_vccnz L_fw_c_slow
L_fw_c_ok:
    s_add_u32 m0, s93, 0
    s_add_u32 s94, s92, 0
    buffer_load_dwordx4 v1, s[8:11], s94 offen offset:0 sc1 lds
    buffer_load_dwordx4 v1, s[8:11], s94 offen offset:1024 sc1 lds
    buffer_load_dwordx4 v1, s[8:11], s94 offen offset:2048 sc1 lds
    buffer_load_dwordx4 v1, s[8:11], s94 offen offset:3072 sc1 lds
    s_add_u32 m0, s93, 16384
    s_add_u32 s94, s92, 16384
    buffer_load_dwordx4 v1, s[8:11], s94 offen offset:0 sc1 lds
    buffer_load_dwordx4 v1, s[8:11], s94 offen offset:1024 sc1 lds
    buffer_load_dwordx4 v1, s[8:11], s94 offen offset:2048 sc1 lds
    buffer_load_dwordx4 v1, s[8:11], s94 offen offset:3072 sc1 lds
    v_add_u32 v4, 0x10000, v1
    v_add_u32 v5, 0x20000, v1
    v_bfe_u32 v2, v0, 4, 1
    v_mul_u32_u24 v2, 57344, v2
    v_lshrrev_b32 v236, 5, v0
    v_lshl_add_u32 v2, v236, 8, v2
    v_lshrrev_b32 v3, 2, v0
    v_lshlrev_b32 v3, 6, v3
    v_and_b32 v7, 3, v0
    v_lshl_add_u32 v3, v7, 3, v3
    v_and_b32 v7, 15, v0
    v_lshlrev_b32 v7, 4, v7
    v_add_u32 v2, v2, v7
    v_lshrrev_b32 v236, 4, v0
    v_lshl_add_u32 v6, v236, 9, v7
    v_lshl_add_u32 v7, v236, 8, v7
    v_and_b32 v254, 3, v0
    v_mul_u32_u24 v254, 128, v254
    s_branch L_ring
L_side:
    s_load_dwordx2 s[12:13], s[0:1], 0
    s_mov_b32 s14, 2621440
    s_mov_b32 s15, 0x20000
    s_load_dwordx2 s[16:17], s[0:1], 56
    s_mov_b32 s18, 2211840
    s_mov_b32 s19, 0x20000
    s_load_dwordx2 s[20:21], s[0:1], 64
    s_mov_b32 s22, 2211840
    s_mov_b32 s23, 0x20000
    s_load_dwordx2 s[8:9], s[0:1], 96
    s_mov_b32 s10, 22937600
    s_mov_b32 s11, 0x20000
    s_load_dwordx2 s[48:49], s[0:1], 80
    s_mov_b32 s50, 2621440
    s_mov_b32 s51, 0x20000
    s_load_dwordx2 s[52:53], s[0:1], 88
    s_mov_b32 s54, 256
    s_mov_b32 s55, 0x20000
    v_lshrrev_b32 v1, 6, v0
    s_and_b32 s4, s2, 7
    v_readfirstlane_b32 s33, v1
    s_lshr_b32 s5, s2, 3
    v_and_b32 v0, 63, v0
    s_mov_b32 s59, 0xffff0000
    v_mov_b32 v6, 0x80000000
    v_mov_b32 v7, 1
    v_writelane_b32 v6, 0, 0
    v_and_b32 v122, 7, v0
    v_lshlrev_b32 v122, 5, v122
    s_cmp_ge_u32 s5, 28
    s_cbranch_scc1 L_side2
    s_sub_u32 s56, s2, 160
    s_sub_u32 s43, s5, 20
    s_mov_b32 s7, s4
    s_mul_i32 s6, s7, 3
    s_and_b32 s58, s7, 1
    s_lshr_b32 s57, s7, 1
    s_sub_u32 s6, s6, s57
    v_lshrrev_b32 v13, 4, v0
    v_and_b32 v12, 15, v0
    s_lshl_b32 s38, s56, 2
    s_add_u32 s38, s38, s33
    s_mul_i32 s34, s38, 10240
    s_add_u32 s35, s34, 5120
    v_mul_u32_u24 v1, 1280, v13
    v_lshl_add_u32 v1, v12, 4, v1
    v_lshlrev_b32 v4, 4, v0
    s_waitcnt lgkmcnt(0)
    buffer_load_dwordx4 v[16:19], v1, s[12:15], s34 offen offset:0
    buffer_load_dwordx4 v[20:23], v1, s[12:15], s34 offen offset:256
    buffer_load_dwordx4 v[24:27], v1, s[12:15], s34 offen offset:512
    buffer_load_dwordx4 v[28:31], v1, s[12:15], s34 offen offset:768
    buffer_load_dwordx4 v[32:35], v1, s[12:15], s34 offen offset:1024
    buffer_load_dwordx4 v[36:39], v1, s[12:15], s35 offen offset:0
    buffer_load_dwordx4 v[40:43], v1, s[12:15], s35 offen offset:256
    buffer_load_dwordx4 v[44:47], v1, s[12:15], s35 offen offset:512
    buffer_load_dwordx4 v[48:51], v1, s[12:15], s35 offen offset:768
    buffer_load_dwordx4 v[52:55], v1, s[12:15], s35 offen offset:1024
    s_mul_i32 s36, s33, 10368
    v_mul_u32_u24 v2, 1296, v13
    v_lshl_add_u32 v2, v12, 4, v2
    v_add_u32 v2, s36, v2
    s_mul_i32 s36, s33, 320
    v_mul_u32_u24 v3, 1296, v12
    v_lshl_add_u32 v3, v13, 3, v3
    v_add_u32 v3, s36, v3
    s_add_u32 s37, s34, 2621440
    s_and_b32 s36, s33, 1
    s_lshl_b32 s36, s36, 7
    s_lshr_b32 s39, s33, 1
    s_lshl_b32 s39, s39, 3
    s_add_u32 s36, s36, s39
    v_lshlrev_b32 v5, 4, v13
    v_add_u32 v5, s36, v5
    v_lshlrev_b32 v8, 2, v0
    s_lshl_b32 s36, s56, 8
    s_add_u32 s36, s36, 7864320
    s_cmp_eq_u32 s33, 0
    s_cselect_b32 s36, s36, 0x70000000
    s_mov_b32 s40, 1065369472
    s_lshl_b32 s38, s38, 10
    s_add_u32 s38, s38, 22413312
    v_mov_b32 v96, 0
    v_mov_b32 v97, 0
    v_mov_b32 v98, 0
    v_mov_b32 v99, 0
    buffer_store_dwordx4 v[96:99], v4, s[8:11], s38 offen sc1
    s_add_u32 s38, s38, 4279762944
    v_mov_b32 v112, -1
    v_mov_b32 v113, -1
    v_mov_b32 v114, -1
    v_mov_b32 v115, -1
    buffer_store_dwordx4 v[112:115], v4, s[8:11], s38 offen sc1
    s_add_u32 s38, s38, 262144
    buffer_store_dwordx4 v[112:115], v4, s[8:11], s38 offen sc1
    s_add_u32 s38, s38, 262144
    s_cmp_lt_u32 s56, 32
    s_cselect_b32 s38, s38, 0x70000000
    buffer_store_dwordx4 v[112:115], v4, s[8:11], s38 offen sc1
    s_add_u32 s38, s38, 262144
    s_waitcnt vmcnt(13)
    ds_write_b128 v2, v[16:19] offset:0
    s_waitcnt vmcnt(12)
    ds_write_b128 v2, v[20:23] offset:256
    s_waitcnt vmcnt(11)
    ds_write_b128 v2, v[24:27] offset:512
    s_waitcnt vmcnt(10)
    ds_write_b128 v2, v[28:31] offset:768
    s_waitcnt vmcnt(9)
    ds_write_b128 v2, v[32:35] offset:1024
    s_waitcnt vmcnt(8)
    ds_write_b128 v2, v[36:39] offset:5184
    s_waitcnt vmcnt(7)
    ds_write_b128 v2, v[40:43] offset:5440
    s_waitcnt vmcnt(6)
    ds_write_b128 v2, v[44:47] offset:5696
    s_waitcnt vmcnt(5)
    ds_write_b128 v2, v[48:51] offset:5952
    s_waitcnt vmcnt(4)
    ds_write_b128 v2, v[52:55] offset:6208
    s_waitcnt lgkmcnt(0)
    s_barrier
    ds_read_b64 v[56:57], v3 offset:0
    ds_read_b64 v[58:59], v3 offset:20736
    ds_read_b64 v[60:61], v3 offset:32
    ds_read_b64 v[62:63], v3 offset:20768
    ds_read_b64 v[64:65], v3 offset:64
    ds_read_b64 v[66:67], v3 offset:20800
    ds_read_b64 v[68:69], v3 offset:96
    ds_read_b64 v[70:71], v3 offset:20832
    ds_read_b64 v[72:73], v3 offset:128
    ds_read_b64 v[74:75], v3 offset:20864
    ds_read_b64 v[76:77], v3 offset:160
    ds_read_b64 v[78:79], v3 offset:20896
    ds_read_b64 v[80:81], v3 offset:192
    ds_read_b64 v[82:83], v3 offset:20928
    ds_read_b64 v[84:85], v3 offset:224
    ds_read_b64 v[86:87], v3 offset:20960
    ds_read_b64 v[88:89], v3 offset:256
    ds_read_b64 v[90:91], v3 offset:20992
    ds_read_b64 v[92:93], v3 offset:288
    ds_read_b64 v[94:95], v3 offset:21024
    s_waitcnt lgkmcnt(15)
    buffer_store_dwordx4 v[56:59], v4, s[8:11], s37 offen offset:0 sc1
    v_dot2_f32_bf16 v100, v16, s40, 0
    v_dot2_f32_bf16 v101, v16, v16, 0
    s_nop 1
    v_dot2c_f32_bf16 v100, s40, v17
    v_dot2c_f32_bf16 v101, v17, v17
    v_dot2c_f32_bf16 v100, s40, v18
    v_dot2c_f32_bf16 v101, v18, v18
    v_dot2c_f32_bf16 v100, s40, v19
    v_dot2c_f32_bf16 v101, v19, v19
    buffer_store_dwordx4 v[60:63], v4, s[8:11], s37 offen offset:1024 sc1
    v_dot2c_f32_bf16 v100, s40, v20
    v_dot2c_f32_bf16 v101, v20, v20
    v_dot2c_f32_bf16 v100, s40, v21
    v_dot2c_f32_bf16 v101, v21, v21
    v_dot2c_f32_bf16 v100, s40, v22
    v_dot2c_f32_bf16 v101, v22, v22
    v_dot2c_f32_bf16 v100, s40, v23
    v_dot2c_f32_bf16 v101, v23, v23
    s_waitcnt lgkmcnt(14)
    buffer_store_dwordx4 v[64:67], v4, s[8:11], s37 offen offset:2048 sc1
    v_dot2c_f32_bf16 v100, s40, v24
    v_dot2c_f32_bf16 v101, v24, v24
    v_dot2c_f32_bf16 v100, s40, v25
    v_dot2c_f32_bf16 v101, v25, v25
    v_dot2c_f32_bf16 v100, s40, v26
    v_dot2c_f32_bf16 v101, v26, v26
    v_dot2c_f32_bf16 v100, s40, v27
    v_dot2c_f32_bf16 v101, v27, v27
    s_waitcnt lgkmcnt(12)
    buffer_store_dwordx4 v[68:71], v4, s[8:11], s37 offen offset:3072 sc1
    v_dot2c_f32_bf16 v100, s40, v28
    v_dot2c_f32_bf16 v101, v28, v28
    v_dot2c_f32_bf16 v100, s40, v29
    v_dot2c_f32_bf16 v101, v29, v29
    v_dot2c_f32_bf16 v100, s40, v30
    v_dot2c_f32_bf16 v101, v30, v30
    v_dot2c_f32_bf16 v100, s40, v31
    v_dot2c_f32_bf16 v101, v31, v31
    s_addk_i32 s37, 4096
    s_waitcnt lgkmcnt(10)
    buffer_store_dwordx4 v[72:75], v4, s[8:11], s37 offen offset:0 sc1
    v_dot2c_f32_bf16 v100, s40, v32
    v_dot2c_f32_bf16 v101, v32, v32
    v_dot2c_f32_bf16 v100, s40, v33
    v_dot2c_f32_bf16 v101, v33, v33
    v_dot2c_f32_bf16 v100, s40, v34
    v_dot2c_f32_bf16 v101, v34, v34
    v_dot2c_f32_bf16 v100, s40, v35
    v_dot2c_f32_bf16 v101, v35, v35
    s_waitcnt lgkmcnt(8)
    buffer_store_dwordx4 v[76:79], v4, s[8:11], s37 offen offset:1024 sc1
    v_dot2_f32_bf16 v102, v36, s40, 0
    v_dot2_f32_bf16 v103, v36, v36, 0
    s_nop 1
    v_dot2c_f32_bf16 v102, s40, v37
    v_dot2c_f32_bf16 v103, v37, v37
    v_dot2c_f32_bf16 v102, s40, v38
    v_dot2c_f32_bf16 v103, v38, v38
    v_dot2c_f32_bf16 v102, s40, v39
    v_dot2c_f32_bf16 v103, v39, v39
    s_waitcnt lgkmcnt(6)
    buffer_store_dwordx4 v[80:83], v4, s[8:11], s37 offen offset:2048 sc1
    v_dot2c_f32_bf16 v102, s40, v40
    v_dot2c_f32_bf16 v103, v40, v40
    v_dot2c_f32_bf16 v102, s40, v41
    v_dot2c_f32_bf16 v103, v41, v41
    v_dot2c_f32_bf16 v102, s40, v42
    v_dot2c_f32_bf16 v103, v42, v42
    v_dot2c_f32_bf16 v102, s40, v43
    v_dot2c_f32_bf16 v103, v43, v43
    s_waitcnt lgkmcnt(4)
    buffer_store_dwordx4 v[84:87], v4, s[8:11], s37 offen offset:3072 sc1
    v_dot2c_f32_bf16 v102, s40, v44
    v_dot2c_f32_bf16 v103, v44, v44
    v_dot2c_f32_bf16 v102, s40, v45
    v_dot2c_f32_bf16 v103, v45, v45
    v_dot2c_f32_bf16 v102, s40, v46
    v_dot2c_f32_bf16 v103, v46, v46
    v_dot2c_f32_bf16 v102, s40, v47
    v_dot2c_f32_bf16 v103, v47, v47
    s_addk_i32 s37, 4096
    s_waitcnt lgkmcnt(2)
    buffer_store_dwordx4 v[88:91], v4, s[8:11], s37 offen offset:0 sc1
    v_dot2c_f32_bf16 v102, s40, v48
    v_dot2c_f32_bf16 v103, v48, v48
    v_dot2c_f32_bf16 v102, s40, v49
    v_dot2c_f32_bf16 v103, v49, v49
    v_dot2c_f32_bf16 v102, s40, v50
    v_dot2c_f32_bf16 v103, v50, v50
    v_dot2c_f32_bf16 v102, s40, v51
    v_dot2c_f32_bf16 v103, v51, v51
    s_waitcnt lgkmcnt(0)
    buffer_store_dwordx4 v[92:95], v4, s[8:11], s37 offen offset:1024 sc1
    v_dot2c_f32_bf16 v102, s40, v52
    v_dot2c_f32_bf16 v103, v52, v52
    v_dot2c_f32_bf16 v102, s40, v53
    v_dot2c_f32_bf16 v103, v53, v53
    v_dot2c_f32_bf16 v102, s40, v54
    v_dot2c_f32_bf16 v103, v54, v54
    v_dot2c_f32_bf16 v102, s40, v55
    v_dot2c_f32_bf16 v103, v55, v55
    v_add_f32_dpp v100, v100, v100 row_ror:8 row_mask:0xf bank_mask:0xf
    v_add_f32_dpp v101, v101, v101 row_ror:8 row_mask:0xf bank_mask:0xf
    v_add_f32_dpp v102, v102, v102 row_ror:8 row_mask:0xf bank_mask:0xf
    v_add_f32_dpp v103, v103, v103 row_ror:8 row_mask:0xf bank_mask:0xf
    v_add_f32_dpp v100, v100, v100 row_ror:4 row_mask:0xf bank_mask:0xf
    v_add_f32_dpp v101, v101, v101 row_ror:4 row_mask:0xf bank_mask:0xf
    v_add_f32_dpp v102, v102, v102 row_ror:4 row_mask:0xf bank_mask:0xf
    v_add_f32_dpp v103, v103, v103 row_ror:4 row_mask:0xf bank_mask:0xf
    v_add_f32_dpp v100, v100, v100 row_ror:2 row_mask:0xf bank_mask:0xf
    v_add_f32_dpp v101, v101, v101 row_ror:2 row_mask:0xf bank_mask:0xf
    v_add_f32_dpp v102, v102, v102 row_ror:2 row_mask:0xf bank_mask:0xf
    v_add_f32_dpp v103, v103, v103 row_ror:2 row_mask:0xf bank_mask:0xf
    v_add_f32_dpp v100, v100, v100 row_ror:1 row_mask:0xf bank_mask:0xf
    v_add_f32_dpp v101, v101, v101 row_ror:1 row_mask:0xf bank_mask:0xf
    v_add_f32_dpp v102, v102, v102 row_ror:1 row_mask:0xf bank_mask:0xf
    v_add_f32_dpp v103, v103, v103 row_ror:1 row_mask:0xf bank_mask:0xf
    v_mul_f32 v100, 0xbacccccd, v100
    v_mul_f32 v101, 0x3acccccd, v101
    v_fma_f32 v101, -v100, v100, v101
    v_max_f32 v101, 0, v101
    v_add_f32 v101, 0x3727c5ac, v101
    v_rsq_f32 v108, v101
    v_mul_f32 v102, 0xbacccccd, v102
    v_mul_f32 v103, 0x3acccccd, v103
    v_fma_f32 v103, -v102, v102, v103
    v_max_f32 v103, 0, v103
    v_add_f32 v103, 0x3727c5ac, v103
    v_rsq_f32 v110, v103
    v_mul_f32 v109, v100, v108
    ds_write_b64 v5, v[108:109] offset:41472
    v_mul_f32 v111, v102, v110
    ds_write_b64 v5, v[110:111] offset:41536
    s_waitcnt lgkmcnt(0)
    s_barrier
    ds_read_b32 v10, v8 offset:41472
    s_waitcnt lgkmcnt(0)
    buffer_store_dword v10, v8, s[8:11], s36 offen sc1
    buffer_load_dword v123, v122, s[52:55], 0 offen sc1
    s_mul_i32 s56, s56, 128
    s_add_u32 s56, s56, 22364160
    v_mul_u32_u24 v116, 147, v0
    v_lshrrev_b32 v116, 11, v116
    v_mul_u32_u24 v117, 14, v116
    v_sub_u32 v117, v0, v117
    v_lshlrev_b32 v117, 4, v117
    v_and_b32 v118, 1, v116
    v_mul_u32_u24 v118, 216, v118
    v_lshrrev_b32 v116, 1, v116
    v_mul_u32_u24 v116, 3456, v116
    v_add3_u32 v116, v116, v117, v118
    s_lshl_b32 s46, s6, 2
    s_add_u32 s46, s46, s33
    s_mul_i32 s46, s46, 13824
    s_mul_i32 s47, s43, 432
    s_add_u32 s46, s46, s47
    s_mul_i32 s47, s33, 1792
    s_add_u32 s47, s47, 49152
    s_mov_b32 exec_hi, 0x00ffffff
    s_add_u32 s45, s46, 0
    s_add_u32 m0, s47, 0
    s_nop 0
    buffer_load_dwordx4 v116, s[16:19], s45 offen lds
    s_add_u32 m0, s47, 21536
    s_nop 0
    buffer_load_dwordx4 v116, s[20:23], s45 offen lds
    s_add_u32 s45, s46, 6912
    s_add_u32 m0, s47, 896
    s_nop 0
    buffer_load_dwordx4 v116, s[16:19], s45 offen lds
    s_add_u32 m0, s47, 22432
    s_nop 0
    buffer_load_dwordx4 v116, s[20:23], s45 offen lds
    s_mov_b64 exec, -1
    s_mul_i32 s47, s33, 1792
    s_add_u32 s47, s47, 49152
    v_and_b32 v2, 7, v0
    v_mul_u32_u24 v2, 224, v2
    v_bfe_u32 v3, v0, 3, 1
    v_sub_u32 v8, 1, v3
    v_mul_u32_u24 v8, 0x3f80, v8
    v_mov_b32 v9, 0
    v_mul_u32_u24 v3, 21536, v3
    v_add3_u32 v2, v2, v3, s47
    v_lshrrev_b32 v12, 5, v0
    v_bfe_u32 v13, v0, 2, 2
    v_lshl_add_u32 v3, v12, 3, v13
    v_mul_u32_u24 v3, 448, v3
    v_bfe_u32 v13, v0, 4, 1
    v_mul_u32_u24 v13, 21536, v13
    v_add_u32 v3, v3, v13
    v_and_b32 v13, 3, v0
    v_lshl_add_u32 v3, v13, 3, v3
    v_and_b32 v11, 15, v0
    v_lshlrev_b32 v11, 4, v11
    v_lshl_add_u32 v11, v12, 8, v11
    v_and_b32 v13, 16, v0
    v_lshl_add_u32 v11, v13, 6, v11
    s_lshl_b32 s36, s33, 5
    s_add_u32 s36, s36, 49152
    v_add_u32 v3, s36, v3
    v_lshlrev_b32 v4, 4, v0
    s_lshl_b32 s36, s33, 9
    v_lshl_add_u32 v5, v0, 1, s36
    v_add_u32 v10, s36, v4
    s_mov_b32 s44, 1065369472
    s_mul_i32 s26, s43, 589824
    s_add_u32 s26, s26, 7929856
    s_mov_b32 s34, 2048
    s_mov_b32 s38, 4096
    s_mov_b32 s28, 82944
    s_cmp_eq_u32 s33, 1
    s_cselect_b32 s34, 83968, s34
    s_cselect_b32 s38, 2048, s38
    s_cselect_b32 s28, 124928, s28
    s_cmp_eq_u32 s33, 2
    s_cselect_b32 s34, 125952, s34
    s_cselect_b32 s38, 2048, s38
    s_cselect_b32 s28, 166912, s28
    s_cmp_eq_u32 s33, 3
    s_cselect_b32 s34, 167936, s34
    s_cselect_b32 s38, 2048, s38
    s_cselect_b32 s28, 208896, s28
    s_add_u32 s34, s34, s26
    s_add_u32 s28, s28, s26
    s_lshl_b32 s42, s7, 6
    s_add_u32 s28, s28, s42
    s_mov_b32 s35, 209920
    s_mov_b32 s39, 2048
    s_mov_b32 s29, 250880
    s_cmp_eq_u32 s33, 1
    s_cselect_b32 s35, 251904, s35
    s_cselect_b32 s39, 2048, s39
    s_cselect_b32 s29, 292864, s29
    s_cmp_eq_u32 s33, 2
    s_cselect_b32 s35, 0, s35
    s_cselect_b32 s39, 4096, s39
    s_cselect_b32 s29, 81920, s29
    s_cmp_eq_u32 s33, 3
    s_cselect_b32 s35, 296960, s35
    s_cselect_b32 s39, 4096, s39
    s_cselect_b32 s29, 377856, s29
    s_add_u32 s35, s35, s26
    s_add_u32 s29, s29, s26
    s_lshl_b32 s42, s7, 6
    s_add_u32 s29, s29, s42
    s_mov_b32 s36, 378880
    s_mov_b32 s40, 2048
    s_mov_b32 s30, 419840
    s_cmp_eq_u32 s33, 1
    s_cselect_b32 s36, 420864, s36
    s_cselect_b32 s40, 2048, s40
    s_cselect_b32 s30, 461824, s30
    s_cmp_eq_u32 s33, 2
    s_cselect_b32 s36, 462848, s36
    s_cselect_b32 s40, 2048, s40
    s_cselect_b32 s30, 503808, s30
    s_cmp_eq_u32 s33, 3
    s_cselect_b32 s36, 504832, s36
    s_cselect_b32 s40, 2048, s40
    s_cselect_b32 s30, 545792, s30
    s_add_u32 s36, s36, s26
    s_add_u32 s30, s30, s26
    s_lshl_b32 s42, s7, 6
    s_add_u32 s30, s30, s42
    s_mov_b32 s37, 546816
    s_mov_b32 s41, 2048
    s_mov_b32 s31, 587776
    s_cmp_eq_u32 s33, 1
    s_cselect_b32 s37, 294912, s37
    s_cselect_b32 s41, 4096, s41
    s_cselect_b32 s31, 376832, s31
    s_cmp_eq_u32 s33, 2
    s_cselect_b32 s37, 1073741824, s37
    s_cselect_b32 s41, 0, s41
    s_cselect_b32 s31, 1073741824, s31
    s_cmp_eq_u32 s33, 3
    s_cselect_b32 s37, 1073741824, s37
    s_cselect_b32 s41, 0, s41
    s_cselect_b32 s31, 1073741824, s31
    s_add_u32 s37, s37, s26
    s_add_u32 s31, s31, s26
    s_lshl_b32 s42, s7, 6
    s_add_u32 s31, s31, s42
    s_waitcnt vmcnt(4)
    v_cmp_gt_u32 vcc, 1, v123
    s_nop 0
    s_cbranch_vccnz L_go_a_slow
L_go_a_ok:
    s_barrier
    s_cmp_eq_u32 s33, 0
    s_cselect_b32 s42, s56, 0x7f000000
    buffer_store_dword v7, v6, s[8:11], s42 offen sc1
    s_mov_b32 exec_hi, 0x00ffffff
    s_add_u32 s45, s46, 55296
    s_add_u32 m0, s47, 7168
    s_nop 0
    buffer_load_dwordx4 v116, s[16:19], s45 offen lds
    s_add_u32 m0, s47, 28704
    s_nop 0
    buffer_load_dwordx4 v116, s[20:23], s45 offen lds
    s_add_u32 s45, s46, 62208
    s_add_u32 m0, s47, 8064
    s_nop 0
    buffer_load_dwordx4 v116, s[16:19], s45 offen lds
    s_add_u32 m0, s47, 29600
    s_nop 0
    buffer_load_dwordx4 v116, s[20:23], s45 offen lds
    s_mul_i32 s45, s58, 165888
    s_sub_u32 s46, s46, s45
    s_lshr_b32 s45, s33, 1
    s_cmp_eq_u32 s45, s58
    s_cselect_b32 s46, s46, 0x70000000
    s_add_u32 s45, s46, 110592
    s_add_u32 m0, s47, 14336
    s_nop 0
    buffer_load_dwordx4 v116, s[16:19], s45 offen lds
    s_add_u32 m0, s47, 35872
    s_nop 0
    buffer_load_dwordx4 v116, s[20:23], s45 offen lds
    s_add_u32 s45, s46, 117504
    s_add_u32 m0, s47, 15232
    s_nop 0
    buffer_load_dwordx4 v116, s[16:19], s45 offen lds
    s_add_u32 m0, s47, 36768
    s_nop 0
    buffer_load_dwordx4 v116, s[20:23], s45 offen lds
    s_mov_b64 exec, -1
    s_waitcnt vmcnt(9)
    ds_write_b64 v2, v[8:9] offset:216
    s_waitcnt lgkmcnt(0)
    s_barrier
    ds_read_b64_tr_b16 v[16:17], v3 offset:0
    ds_read_b64_tr_b16 v[18:19], v3 offset:1792
    ds_read_b64_tr_b16 v[20:21], v3 offset:128
    ds_read_b64_tr_b16 v[22:23], v3 offset:1920
    ds_read_b64_tr_b16 v[24:25], v3 offset:256
    ds_read_b64_tr_b16 v[26:27], v3 offset:2048
    ds_read_b64_tr_b16 v[28:29], v3 offset:384
    ds_read_b64_tr_b16 v[30:31], v3 offset:2176
    s_add_u32 s24, s6, 0
    s_and_b32 s25, s24, 1
    s_lshl_b32 s25, s25, 9
    s_lshr_b32 s24, s24, 1
    s_mul_i32 s42, s24, s38
    s_add_u32 s42, s42, s25
    s_add_u32 s42, s42, s34
    s_waitcnt lgkmcnt(6)
    buffer_store_dwordx4 v[16:19], v11, s[8:11], s42 offen sc1
    v_dot2_f32_bf16 v100, v16, s44, 0
    s_nop 2
    v_dot2c_f32_bf16 v100, s44, v17
    v_dot2c_f32_bf16 v100, s44, v18
    v_dot2c_f32_bf16 v100, s44, v19
    s_mul_i32 s42, s24, s39
    s_add_u32 s42, s42, s25
    s_add_u32 s42, s42, s35
    s_waitcnt lgkmcnt(4)
    buffer_store_dwordx4 v[20:23], v11, s[8:11], s42 offen sc1
    v_dot2_f32_bf16 v101, v20, s44, 0
    s_nop 2
    v_dot2c_f32_bf16 v101, s44, v21
    v_dot2c_f32_bf16 v101, s44, v22
    v_dot2c_f32_bf16 v101, s44, v23
    s_mul_i32 s42, s24, s40
    s_add_u32 s42, s42, s25
    s_add_u32 s42, s42, s36
    s_waitcnt lgkmcnt(2)
    buffer_store_dwordx4 v[24:27], v11, s[8:11], s42 offen sc1
    v_dot2_f32_bf16 v102, v24, s44, 0
    s_nop 2
    v_dot2c_f32_bf16 v102, s44, v25
    v_dot2c_f32_bf16 v102, s44, v26
    v_dot2c_f32_bf16 v102, s44, v27
    s_mul_i32 s42, s24, s41
    s_add_u32 s42, s42, s25
    s_add_u32 s42, s42, s37
    s_waitcnt lgkmcnt(0)
    buffer_store_dwordx4 v[28:31], v11, s[8:11], s42 offen sc1
    v_dot2_f32_bf16 v103, v28, s44, 0
    s_nop 2
    v_dot2c_f32_bf16 v103, s44, v29
    v_dot2c_f32_bf16 v103, s44, v30
    v_dot2c_f32_bf16 v103, s44, v31
    s_waitcnt vmcnt(8)
    ds_write_b64 v2, v[8:9] offset:7384
    s_waitcnt lgkmcnt(0)
    s_barrier
    ds_read_b64_tr_b16 v[32:33], v3 offset:7168
    ds_read_b64_tr_b16 v[34:35], v3 offset:8960
    ds_read_b64_tr_b16 v[36:37], v3 offset:7296
    ds_read_b64_tr_b16 v[38:39], v3 offset:9088
    ds_read_b64_tr_b16 v[40:41], v3 offset:7424
    ds_read_b64_tr_b16 v[42:43], v3 offset:9216
    ds_read_b64_tr_b16 v[44:45], v3 offset:7552
    ds_read_b64_tr_b16 v[46:47], v3 offset:9344
    s_add_u32 s24, s6, 1
    s_and_b32 s25, s24, 1
    s_lshl_b32 s25, s25, 9
    s_lshr_b32 s24, s24, 1
    s_mul_i32 s42, s24, s38
    s_add_u32 s42, s42, s25
    s_add_u32 s42, s42, s34
    s_waitcnt lgkmcnt(6)
    buffer_store_dwordx4 v[32:35], v11, s[8:11], s42 offen sc1
    v_dot2c_f32_bf16 v100, s44, v32
    v_dot2c_f32_bf16 v100, s44, v33
    v_dot2c_f32_bf16 v100, s44, v34
    v_dot2c_f32_bf16 v100, s44, v35
    s_mul_i32 s42, s24, s39
    s_add_u32 s42, s42, s25
    s_add_u32 s42, s42, s35
    s_waitcnt lgkmcnt(4)
    buffer_store_dwordx4 v[36:39], v11, s[8:11], s42 offen sc1
    v_dot2c_f32_bf16 v101, s44, v36
    v_dot2c_f32_bf16 v101, s44, v37
    v_dot2c_f32_bf16 v101, s44, v38
    v_dot2c_f32_bf16 v101, s44, v39
    s_mul_i32 s42, s24, s40
    s_add_u32 s42, s42, s25
    s_add_u32 s42, s42, s36
    s_waitcnt lgkmcnt(2)
    buffer_store_dwordx4 v[40:43], v11, s[8:11], s42 offen sc1
    v_dot2c_f32_bf16 v102, s44, v40
    v_dot2c_f32_bf16 v102, s44, v41
    v_dot2c_f32_bf16 v102, s44, v42
    v_dot2c_f32_bf16 v102, s44, v43
    s_mul_i32 s42, s24, s41
    s_add_u32 s42, s42, s25
    s_add_u32 s42, s42, s37
    s_waitcnt lgkmcnt(0)
    buffer_store_dwordx4 v[44:47], v11, s[8:11], s42 offen sc1
    v_dot2c_f32_bf16 v103, s44, v44
    v_dot2c_f32_bf16 v103, s44, v45
    v_dot2c_f32_bf16 v103, s44, v46
    v_dot2c_f32_bf16 v103, s44, v47
    s_waitcnt vmcnt(8)
    ds_write_b64 v2, v[8:9] offset:14552
    s_waitcnt lgkmcnt(0)
    s_barrier
    ds_read_b64_tr_b16 v[48:49], v3 offset:14336
    ds_read_b64_tr_b16 v[50:51], v3 offset:16128
    ds_read_b64_tr_b16 v[52:53], v3 offset:14464
    ds_read_b64_tr_b16 v[54:55], v3 offset:16256
    ds_read_b64_tr_b16 v[56:57], v3 offset:14592
    ds_read_b64_tr_b16 v[58:59], v3 offset:16384
    ds_read_b64_tr_b16 v[60:61], v3 offset:14720
    ds_read_b64_tr_b16 v[62:63], v3 offset:16512
    s_add_u32 s24, s6, 2
    s_mul_i32 s25, s58, 3
    s_sub_u32 s24, s24, s25
    v_xor_b32 v12, s58, v12
    v_lshl_add_u32 v11, v12, 30, v11
    s_and_b32 s25, s24, 1
    s_lshl_b32 s25, s25, 9
    s_lshr_b32 s24, s24, 1
    s_mul_i32 s42, s24, s38
    s_add_u32 s42, s42, s25
    s_add_u32 s42, s42, s34
    s_waitcnt lgkmcnt(6)
    buffer_store_dwordx4 v[48:51], v11, s[8:11], s42 offen sc1
    v_dot2c_f32_bf16 v100, s44, v48
    v_dot2c_f32_bf16 v100, s44, v49
    v_dot2c_f32_bf16 v100, s44, v50
    v_dot2c_f32_bf16 v100, s44, v51
    s_mul_i32 s42, s24, s39
    s_add_u32 s42, s42, s25
    s_add_u32 s42, s42, s35
    s_waitcnt lgkmcnt(4)
    buffer_store_dwordx4 v[52:55], v11, s[8:11], s42 offen sc1
    v_dot2c_f32_bf16 v101, s44, v52
    v_dot2c_f32_bf16 v101, s44, v53
    v_dot2c_f32_bf16 v101, s44, v54
    v_dot2c_f32_bf16 v101, s44, v55
    s_mul_i32 s42, s24, s40
    s_add_u32 s42, s42, s25
    s_add_u32 s42, s42, s36
    s_waitcnt lgkmcnt(2)
    buffer_store_dwordx4 v[56:59], v11, s[8:11], s42 offen sc1
    v_dot2c_f32_bf16 v102, s44, v56
    v_dot2c_f32_bf16 v102, s44, v57
    v_dot2c_f32_bf16 v102, s44, v58
    v_dot2c_f32_bf16 v102, s44, v59
    s_mul_i32 s42, s24, s41
    s_add_u32 s42, s42, s25
    s_add_u32 s42, s42, s37
    s_waitcnt lgkmcnt(0)
    buffer_store_dwordx4 v[60:63], v11, s[8:11], s42 offen sc1
    v_dot2c_f32_bf16 v103, s44, v60
    v_dot2c_f32_bf16 v103, s44, v61
    v_dot2c_f32_bf16 v103, s44, v62
    v_dot2c_f32_bf16 v103, s44, v63
    v_mov_b32 v104, v100
    v_mov_b32 v105, v101
    v_mov_b32 v106, v102
    v_mov_b32 v107, v103
    v_permlane32_swap_b32 v100, v104
    v_permlane32_swap_b32 v101, v105
    v_permlane32_swap_b32 v102, v106
    v_permlane32_swap_b32 v103, v107
    s_mov_b32 vcc_lo, 0
    s_mov_b32 vcc_hi, -1
    v_add_f32 v100, v100, v104
    v_cvt_pk_bf16_f32 v104, v100, v100
    v_and_b32 v104, s59, v104
    v_sub_f32 v104, v100, v104
    v_cndmask_b32 v100, v100, v104, vcc
    v_cvt_pk_bf16_f32 v100, v100, v100
    ds_write_b16 v5, v100 offset:0
    v_add_f32 v101, v101, v105
    v_cvt_pk_bf16_f32 v105, v101, v101
    v_and_b32 v105, s59, v105
    v_sub_f32 v105, v101, v105
    v_cndmask_b32 v101, v101, v105, vcc
    v_cvt_pk_bf16_f32 v101, v101, v101
    ds_write_b16 v5, v101 offset:128
    v_add_f32 v102, v102, v106
    v_cvt_pk_bf16_f32 v106, v102, v102
    v_and_b32 v106, s59, v106
    v_sub_f32 v106, v102, v106
    v_cndmask_b32 v102, v102, v106, vcc
    v_cvt_pk_bf16_f32 v102, v102, v102
    ds_write_b16 v5, v102 offset:256
    v_add_f32 v103, v103, v107
    v_cvt_pk_bf16_f32 v107, v103, v103
    v_and_b32 v107, s59, v107
    v_sub_f32 v107, v103, v107
    v_cndmask_b32 v103, v103, v107, vcc
    v_cvt_pk_bf16_f32 v103, v103, v103
    ds_write_b16 v5, v103 offset:384
    s_mov_b64 exec, 15
    ds_read_b128 v[104:107], v10 offset:0
    ds_read_b128 v[108:111], v10 offset:128
    ds_read_b128 v[112:115], v10 offset:256
    ds_read_b128 v[116:119], v10 offset:384
    s_waitcnt lgkmcnt(3)
    buffer_store_dwordx4 v[104:107], v4, s[8:11], s28 offen sc1
    s_waitcnt lgkmcnt(2)
    buffer_store_dwordx4 v[108:111], v4, s[8:11], s29 offen sc1
    s_waitcnt lgkmcnt(1)
    buffer_store_dwordx4 v[112:115], v4, s[8:11], s30 offen sc1
    s_waitcnt lgkmcnt(0)
    buffer_store_dwordx4 v[116:119], v4, s[8:11], s31 offen sc1
    s_mov_b64 exec, -1
    s_branch L_w1_done
L_side2:
    s_waitcnt lgkmcnt(0)
    s_sub_u32 s56, s2, 224
    s_lshl_b32 s45, s56, 2
    s_add_u32 s45, s45, s33
    s_lshl_b32 s45, s45, 12
    s_add_u32 s45, s45, 22282240
    s_lshl_b32 s58, s56, 5
    s_cmp_eq_u32 s33, 0
    s_cselect_b32 s58, s58, 0x70000000
    s_cmp_lt_u32 s56, 8
    s_cselect_b32 s45, s45, 0x70000000
    v_lshlrev_b32 v14, 4, v0
    v_mov_b32 v200, 0
    v_mov_b32 v201, 0
    v_mov_b32 v202, 0
    v_mov_b32 v203, 0
    buffer_store_dwordx4 v[200:203], v14, s[8:11], s45 offen offset:0 sc1
    buffer_store_dwordx4 v[200:203], v14, s[8:11], s45 offen offset:1024 sc1
    buffer_store_dwordx4 v[200:203], v14, s[8:11], s45 offen offset:2048 sc1
    buffer_store_dwordx4 v[200:203], v14, s[8:11], s45 offen offset:3072 sc1
    s_and_b32 s43, s4, 1
    s_lshl_b32 s43, s43, 2
    s_add_u32 s43, s43, s5
    s_sub_u32 s43, s43, 28
    s_lshr_b32 s7, s4, 1
    s_mul_i32 s6, s7, 5
    s_add_u32 s6, s6, 20
    s_lshl_b32 s57, s7, 1
    s_add_u32 s57, s57, 8
    s_add_u32 s7, s7, 8
    v_mul_u32_u24 v116, 147, v0
    v_lshrrev_b32 v116, 11, v116
    v_mul_u32_u24 v117, 14, v116
    v_sub_u32 v117, v0, v117
    v_lshlrev_b32 v117, 4, v117
    v_and_b32 v118, 1, v116
    v_mul_u32_u24 v118, 216, v118
    v_lshrrev_b32 v116, 1, v116
    v_mul_u32_u24 v116, 3456, v116
    v_add3_u32 v116, v116, v117, v118
    s_lshl_b32 s46, s6, 2
    s_add_u32 s46, s46, s33
    s_mul_i32 s46, s46, 13824
    s_mul_i32 s47, s43, 432
    s_add_u32 s46, s46, s47
    s_mul_i32 s47, s33, 1792
    s_add_u32 s47, s47, 49152
    s_mov_b32 exec_hi, 0x00ffffff
    s_add_u32 s45, s46, 0
    s_add_u32 m0, s47, 0
    s_nop 0
    buffer_load_dwordx4 v116, s[16:19], s45 offen lds
    s_add_u32 m0, s47, 35872
    s_nop 0
    buffer_load_dwordx4 v116, s[20:23], s45 offen lds
    s_add_u32 s45, s46, 6912
    s_add_u32 m0, s47, 896
    s_nop 0
    buffer_load_dwordx4 v116, s[16:19], s45 offen lds
    s_add_u32 m0, s47, 36768
    s_nop 0
    buffer_load_dwordx4 v116, s[20:23], s45 offen lds
    s_add_u32 s45, s46, 55296
    s_add_u32 m0, s47, 7168
    s_nop 0
    buffer_load_dwordx4 v116, s[16:19], s45 offen lds
    s_add_u32 m0, s47, 43040
    s_nop 0
    buffer_load_dwordx4 v116, s[20:23], s45 offen lds
    s_add_u32 s45, s46, 62208
    s_add_u32 m0, s47, 8064
    s_nop 0
    buffer_load_dwordx4 v116, s[16:19], s45 offen lds
    s_add_u32 m0, s47, 43936
    s_nop 0
    buffer_load_dwordx4 v116, s[20:23], s45 offen lds
    s_mov_b64 exec, -1
    s_mul_i32 s47, s33, 1792
    s_add_u32 s47, s47, 49152
    v_and_b32 v2, 7, v0
    v_mul_u32_u24 v2, 224, v2
    v_bfe_u32 v3, v0, 3, 1
    v_sub_u32 v8, 1, v3
    v_mul_u32_u24 v8, 0x3f80, v8
    v_mov_b32 v9, 0
    v_mul_u32_u24 v3, 35872, v3
    v_add3_u32 v2, v2, v3, s47
    v_lshrrev_b32 v12, 5, v0
    v_bfe_u32 v13, v0, 2, 2
    v_lshl_add_u32 v3, v12, 3, v13
    v_mul_u32_u24 v3, 448, v3
    v_bfe_u32 v13, v0, 4, 1
    v_mul_u32_u24 v13, 35872, v13
    v_add_u32 v3, v3, v13
    v_and_b32 v13, 3, v0
    v_lshl_add_u32 v3, v13, 3, v3
    v_and_b32 v11, 15, v0
    v_lshlrev_b32 v11, 4, v11
    v_lshl_add_u32 v11, v12, 8, v11
    v_and_b32 v13, 16, v0
    v_lshl_add_u32 v11, v13, 6, v11
    s_lshl_b32 s36, s33, 5
    s_add_u32 s36, s36, 49152
    v_add_u32 v3, s36, v3
    v_lshlrev_b32 v4, 4, v0
    s_lshl_b32 s36, s33, 9
    v_lshl_add_u32 v5, v0, 1, s36
    v_add_u32 v10, s36, v4
    s_mov_b32 s44, 1065369472
    s_mul_i32 s26, s43, 589824
    s_add_u32 s26, s26, 7929856
    s_mov_b32 s34, 2048
    s_mov_b32 s38, 4096
    s_mov_b32 s28, 82944
    s_cmp_eq_u32 s33, 1
    s_cselect_b32 s34, 83968, s34
    s_cselect_b32 s38, 2048, s38
    s_cselect_b32 s28, 124928, s28
    s_cmp_eq_u32 s33, 2
    s_cselect_b32 s34, 125952, s34
    s_cselect_b32 s38, 2048, s38
    s_cselect_b32 s28, 166912, s28
    s_cmp_eq_u32 s33, 3
    s_cselect_b32 s34, 167936, s34
    s_cselect_b32 s38, 2048, s38
    s_cselect_b32 s28, 208896, s28
    s_add_u32 s34, s34, s26
    s_add_u32 s28, s28, s26
    s_lshl_b32 s42, s57, 6
    s_add_u32 s28, s28, s42
    s_mov_b32 s35, 209920
    s_mov_b32 s39, 2048
    s_mov_b32 s29, 250880
    s_cmp_eq_u32 s33, 1
    s_cselect_b32 s35, 251904, s35
    s_cselect_b32 s39, 2048, s39
    s_cselect_b32 s29, 292864, s29
    s_cmp_eq_u32 s33, 2
    s_cselect_b32 s35, 0, s35
    s_cselect_b32 s39, 4096, s39
    s_cselect_b32 s29, 81920, s29
    s_cmp_eq_u32 s33, 3
    s_cselect_b32 s35, 296960, s35
    s_cselect_b32 s39, 4096, s39
    s_cselect_b32 s29, 377856, s29
    s_add_u32 s35, s35, s26
    s_add_u32 s29, s29, s26
    s_lshl_b32 s42, s57, 6
    s_add_u32 s29, s29, s42
    s_mov_b32 s36, 378880
    s_mov_b32 s40, 2048
    s_mov_b32 s30, 419840
    s_cmp_eq_u32 s33, 1
    s_cselect_b32 s36, 420864, s36
    s_cselect_b32 s40, 2048, s40
    s_cselect_b32 s30, 461824, s30
    s_cmp_eq_u32 s33, 2
    s_cselect_b32 s36, 462848, s36
    s_cselect_b32 s40, 2048, s40
    s_cselect_b32 s30, 503808, s30
    s_cmp_eq_u32 s33, 3
    s_cselect_b32 s36, 504832, s36
    s_cselect_b32 s40, 2048, s40
    s_cselect_b32 s30, 545792, s30
    s_add_u32 s36, s36, s26
    s_add_u32 s30, s30, s26
    s_lshl_b32 s42, s57, 6
    s_add_u32 s30, s30, s42
    s_mov_b32 s37, 546816
    s_mov_b32 s41, 2048
    s_mov_b32 s31, 587776
    s_cmp_eq_u32 s33, 1
    s_cselect_b32 s37, 294912, s37
    s_cselect_b32 s41, 4096, s41
    s_cselect_b32 s31, 376832, s31
    s_cmp_eq_u32 s33, 2
    s_cselect_b32 s37, 1073741824, s37
    s_cselect_b32 s41, 0, s41
    s_cselect_b32 s31, 1073741824, s31
    s_cmp_eq_u32 s33, 3
    s_cselect_b32 s37, 1073741824, s37
    s_cselect_b32 s41, 0, s41
    s_cselect_b32 s31, 1073741824, s31
    s_add_u32 s37, s37, s26
    s_add_u32 s31, s31, s26
    s_lshl_b32 s42, s57, 6
    s_add_u32 s31, s31, s42
    s_waitcnt vmcnt(8)
    s_barrier
    buffer_store_dword v7, v6, s[52:55], s58 offen sc1
    s_mov_b32 exec_hi, 0x00ffffff
    s_add_u32 s45, s46, 110592
    s_add_u32 m0, s47, 14336
    s_nop 0
    buffer_load_dwordx4 v116, s[16:19], s45 offen lds
    s_add_u32 m0, s47, 50208
    s_nop 0
    buffer_load_dwordx4 v116, s[20:23], s45 offen lds
    s_add_u32 s45, s46, 117504
    s_add_u32 m0, s47, 15232
    s_nop 0
    buffer_load_dwordx4 v116, s[16:19], s45 offen lds
    s_add_u32 m0, s47, 51104
    s_nop 0
    buffer_load_dwordx4 v116, s[20:23], s45 offen lds
    s_add_u32 s45, s46, 165888
    s_add_u32 m0, s47, 21504
    s_nop 0
    buffer_load_dwordx4 v116, s[16:19], s45 offen lds
    s_add_u32 m0, s47, 57376
    s_nop 0
    buffer_load_dwordx4 v116, s[20:23], s45 offen lds
    s_add_u32 s45, s46, 172800
    s_add_u32 m0, s47, 22400
    s_nop 0
    buffer_load_dwordx4 v116, s[16:19], s45 offen lds
    s_add_u32 m0, s47, 58272
    s_nop 0
    buffer_load_dwordx4 v116, s[20:23], s45 offen lds
    s_add_u32 s45, s46, 221184
    s_add_u32 m0, s47, 28672
    s_nop 0
    buffer_load_dwordx4 v116, s[16:19], s45 offen lds
    s_add_u32 m0, s47, 64544
    s_nop 0
    buffer_load_dwordx4 v116, s[20:23], s45 offen lds
    s_add_u32 s45, s46, 228096
    s_add_u32 m0, s47, 29568
    s_nop 0
    buffer_load_dwordx4 v116, s[16:19], s45 offen lds
    s_add_u32 m0, s47, 65440
    s_nop 0
    buffer_load_dwordx4 v116, s[20:23], s45 offen lds
    s_mov_b64 exec, -1
    s_waitcnt vmcnt(17)
    ds_write_b64 v2, v[8:9] offset:216
    s_waitcnt lgkmcnt(0)
    s_barrier
    ds_read_b64_tr_b16 v[16:17], v3 offset:0
    ds_read_b64_tr_b16 v[18:19], v3 offset:1792
    ds_read_b64_tr_b16 v[20:21], v3 offset:128
    ds_read_b64_tr_b16 v[22:23], v3 offset:1920
    ds_read_b64_tr_b16 v[24:25], v3 offset:256
    ds_read_b64_tr_b16 v[26:27], v3 offset:2048
    ds_read_b64_tr_b16 v[28:29], v3 offset:384
    ds_read_b64_tr_b16 v[30:31], v3 offset:2176
    s_add_u32 s24, s6, 0
    s_and_b32 s25, s24, 1
    s_lshl_b32 s25, s25, 9
    s_lshr_b32 s24, s24, 1
    s_mul_i32 s42, s24, s38
    s_add_u32 s42, s42, s25
    s_add_u32 s42, s42, s34
    s_waitcnt lgkmcnt(6)
    buffer_store_dwordx4 v[16:19], v11, s[8:11], s42 offen sc1
    v_dot2_f32_bf16 v100, v16, s44, 0
    s_nop 2
    v_dot2c_f32_bf16 v100, s44, v17
    v_dot2c_f32_bf16 v100, s44, v18
    v_dot2c_f32_bf16 v100, s44, v19
    s_mul_i32 s42, s24, s39
    s_add_u32 s42, s42, s25
    s_add_u32 s42, s42, s35
    s_waitcnt lgkmcnt(4)
    buffer_store_dwordx4 v[20:23], v11, s[8:11], s42 offen sc1
    v_dot2_f32_bf16 v101, v20, s44, 0
    s_nop 2
    v_dot2c_f32_bf16 v101, s44, v21
    v_dot2c_f32_bf16 v101, s44, v22
    v_dot2c_f32_bf16 v101, s44, v23
    s_mul_i32 s42, s24, s40
    s_add_u32 s42, s42, s25
    s_add_u32 s42, s42, s36
    s_waitcnt lgkmcnt(2)
    buffer_store_dwordx4 v[24:27], v11, s[8:11], s42 offen sc1
    v_dot2_f32_bf16 v102, v24, s44, 0
    s_nop 2
    v_dot2c_f32_bf16 v102, s44, v25
    v_dot2c_f32_bf16 v102, s44, v26
    v_dot2c_f32_bf16 v102, s44, v27
    s_mul_i32 s42, s24, s41
    s_add_u32 s42, s42, s25
    s_add_u32 s42, s42, s37
    s_waitcnt lgkmcnt(0)
    buffer_store_dwordx4 v[28:31], v11, s[8:11], s42 offen sc1
    v_dot2_f32_bf16 v103, v28, s44, 0
    s_nop 2
    v_dot2c_f32_bf16 v103, s44, v29
    v_dot2c_f32_bf16 v103, s44, v30
    v_dot2c_f32_bf16 v103, s44, v31
    s_waitcnt vmcnt(17)
    ds_write_b64 v2, v[8:9] offset:7384
    s_waitcnt lgkmcnt(0)
    s_barrier
    ds_read_b64_tr_b16 v[32:33], v3 offset:7168
    ds_read_b64_tr_b16 v[34:35], v3 offset:8960
    ds_read_b64_tr_b16 v[36:37], v3 offset:7296
    ds_read_b64_tr_b16 v[38:39], v3 offset:9088
    ds_read_b64_tr_b16 v[40:41], v3 offset:7424
    ds_read_b64_tr_b16 v[42:43], v3 offset:9216
    ds_read_b64_tr_b16 v[44:45], v3 offset:7552
    ds_read_b64_tr_b16 v[46:47], v3 offset:9344
    s_add_u32 s24, s6, 1
    s_and_b32 s25, s24, 1
    s_lshl_b32 s25, s25, 9
    s_lshr_b32 s24, s24, 1
    s_mul_i32 s42, s24, s38
    s_add_u32 s42, s42, s25
    s_add_u32 s42, s42, s34
    s_waitcnt lgkmcnt(6)
    buffer_store_dwordx4 v[32:35], v11, s[8:11], s42 offen sc1
    v_dot2c_f32_bf16 v100, s44, v32
    v_dot2c_f32_bf16 v100, s44, v33
    v_dot2c_f32_bf16 v100, s44, v34
    v_dot2c_f32_bf16 v100, s44, v35
    s_mul_i32 s42, s24, s39
    s_add_u32 s42, s42, s25
    s_add_u32 s42, s42, s35
    s_waitcnt lgkmcnt(4)
    buffer_store_dwordx4 v[36:39], v11, s[8:11], s42 offen sc1
    v_dot2c_f32_bf16 v101, s44, v36
    v_dot2c_f32_bf16 v101, s44, v37
    v_dot2c_f32_bf16 v101, s44, v38
    v_dot2c_f32_bf16 v101, s44, v39
    s_mul_i32 s42, s24, s40
    s_add_u32 s42, s42, s25
    s_add_u32 s42, s42, s36
    s_waitcnt lgkmcnt(2)
    buffer_store_dwordx4 v[40:43], v11, s[8:11], s42 offen sc1
    v_dot2c_f32_bf16 v102, s44, v40
    v_dot2c_f32_bf16 v102, s44, v41
    v_dot2c_f32_bf16 v102, s44, v42
    v_dot2c_f32_bf16 v102, s44, v43
    s_mul_i32 s42, s24, s41
    s_add_u32 s42, s42, s25
    s_add_u32 s42, s42, s37
    s_waitcnt lgkmcnt(0)
    buffer_store_dwordx4 v[44:47], v11, s[8:11], s42 offen sc1
    v_dot2c_f32_bf16 v103, s44, v44
    v_dot2c_f32_bf16 v103, s44, v45
    v_dot2c_f32_bf16 v103, s44, v46
    v_dot2c_f32_bf16 v103, s44, v47
    s_waitcnt vmcnt(16)
    ds_write_b64 v2, v[8:9] offset:14552
    s_waitcnt lgkmcnt(0)
    s_barrier
    ds_read_b64_tr_b16 v[48:49], v3 offset:14336
    ds_read_b64_tr_b16 v[50:51], v3 offset:16128
    ds_read_b64_tr_b16 v[52:53], v3 offset:14464
    ds_read_b64_tr_b16 v[54:55], v3 offset:16256
    ds_read_b64_tr_b16 v[56:57], v3 offset:14592
    ds_read_b64_tr_b16 v[58:59], v3 offset:16384
    ds_read_b64_tr_b16 v[60:61], v3 offset:14720
    ds_read_b64_tr_b16 v[62:63], v3 offset:16512
    s_add_u32 s24, s6, 2
    s_and_b32 s25, s24, 1
    s_lshl_b32 s25, s25, 9
    s_lshr_b32 s24, s24, 1
    s_mul_i32 s42, s24, s38
    s_add_u32 s42, s42, s25
    s_add_u32 s42, s42, s34
    s_waitcnt lgkmcnt(6)
    buffer_store_dwordx4 v[48:51], v11, s[8:11], s42 offen sc1
    v_dot2c_f32_bf16 v100, s44, v48
    v_dot2c_f32_bf16 v100, s44, v49
    v_dot2c_f32_bf16 v100, s44, v50
    v_dot2c_f32_bf16 v100, s44, v51
    s_mul_i32 s42, s24, s39
    s_add_u32 s42, s42, s25
    s_add_u32 s42, s42, s35
    s_waitcnt lgkmcnt(4)
    buffer_store_dwordx4 v[52:55], v11, s[8:11], s42 offen sc1
    v_dot2c_f32_bf16 v101, s44, v52
    v_dot2c_f32_bf16 v101, s44, v53
    v_dot2c_f32_bf16 v101, s44, v54
    v_dot2c_f32_bf16 v101, s44, v55
    s_mul_i32 s42, s24, s40
    s_add_u32 s42, s42, s25
    s_add_u32 s42, s42, s36
    s_waitcnt lgkmcnt(2)
    buffer_store_dwordx4 v[56:59], v11, s[8:11], s42 offen sc1
    v_dot2c_f32_bf16 v102, s44, v56
    v_dot2c_f32_bf16 v102, s44, v57
    v_dot2c_f32_bf16 v102, s44, v58
    v_dot2c_f32_bf16 v102, s44, v59
    s_mul_i32 s42, s24, s41
    s_add_u32 s42, s42, s25
    s_add_u32 s42, s42, s37
    s_waitcnt lgkmcnt(0)
    buffer_store_dwordx4 v[60:63], v11, s[8:11], s42 offen sc1
    v_dot2c_f32_bf16 v103, s44, v60
    v_dot2c_f32_bf16 v103, s44, v61
    v_dot2c_f32_bf16 v103, s44, v62
    v_dot2c_f32_bf16 v103, s44, v63
    s_waitcnt vmcnt(16)
    ds_write_b64 v2, v[8:9] offset:21720
    s_waitcnt lgkmcnt(0)
    s_barrier
    ds_read_b64_tr_b16 v[64:65], v3 offset:21504
    ds_read_b64_tr_b16 v[66:67], v3 offset:23296
    ds_read_b64_tr_b16 v[68:69], v3 offset:21632
    ds_read_b64_tr_b16 v[70:71], v3 offset:23424
    ds_read_b64_tr_b16 v[72:73], v3 offset:21760
    ds_read_b64_tr_b16 v[74:75], v3 offset:23552
    ds_read_b64_tr_b16 v[76:77], v3 offset:21888
    ds_read_b64_tr_b16 v[78:79], v3 offset:23680
    s_add_u32 s24, s6, 3
    s_and_b32 s25, s24, 1
    s_lshl_b32 s25, s25, 9
    s_lshr_b32 s24, s24, 1
    s_mul_i32 s42, s24, s38
    s_add_u32 s42, s42, s25
    s_add_u32 s42, s42, s34
    s_waitcnt lgkmcnt(6)
    buffer_store_dwordx4 v[64:67], v11, s[8:11], s42 offen sc1
    v_dot2c_f32_bf16 v100, s44, v64
    v_dot2c_f32_bf16 v100, s44, v65
    v_dot2c_f32_bf16 v100, s44, v66
    v_dot2c_f32_bf16 v100, s44, v67
    s_mul_i32 s42, s24, s39
    s_add_u32 s42, s42, s25
    s_add_u32 s42, s42, s35
    s_waitcnt lgkmcnt(4)
    buffer_store_dwordx4 v[68:71], v11, s[8:11], s42 offen sc1
    v_dot2c_f32_bf16 v101, s44, v68
    v_dot2c_f32_bf16 v101, s44, v69
    v_dot2c_f32_bf16 v101, s44, v70
    v_dot2c_f32_bf16 v101, s44, v71
    s_mul_i32 s42, s24, s40
    s_add_u32 s42, s42, s25
    s_add_u32 s42, s42, s36
    s_waitcnt lgkmcnt(2)
    buffer_store_dwordx4 v[72:75], v11, s[8:11], s42 offen sc1
    v_dot2c_f32_bf16 v102, s44, v72
    v_dot2c_f32_bf16 v102, s44, v73
    v_dot2c_f32_bf16 v102, s44, v74
    v_dot2c_f32_bf16 v102, s44, v75
    s_mul_i32 s42, s24, s41
    s_add_u32 s42, s42, s25
    s_add_u32 s42, s42, s37
    s_waitcnt lgkmcnt(0)
    buffer_store_dwordx4 v[76:79], v11, s[8:11], s42 offen sc1
    v_dot2c_f32_bf16 v103, s44, v76
    v_dot2c_f32_bf16 v103, s44, v77
    v_dot2c_f32_bf16 v103, s44, v78
    v_dot2c_f32_bf16 v103, s44, v79
    s_waitcnt vmcnt(16)
    ds_write_b64 v2, v[8:9] offset:28888
    s_waitcnt lgkmcnt(0)
    s_barrier
    ds_read_b64_tr_b16 v[16:17], v3 offset:28672
    ds_read_b64_tr_b16 v[18:19], v3 offset:30464
    ds_read_b64_tr_b16 v[20:21], v3 offset:28800
    ds_read_b64_tr_b16 v[22:23], v3 offset:30592
    ds_read_b64_tr_b16 v[24:25], v3 offset:28928
    ds_read_b64_tr_b16 v[26:27], v3 offset:30720
    ds_read_b64_tr_b16 v[28:29], v3 offset:29056
    ds_read_b64_tr_b16 v[30:31], v3 offset:30848
    s_add_u32 s24, s6, 4
    s_and_b32 s25, s24, 1
    s_lshl_b32 s25, s25, 9
    s_lshr_b32 s24, s24, 1
    s_mul_i32 s42, s24, s38
    s_add_u32 s42, s42, s25
    s_add_u32 s42, s42, s34
    s_waitcnt lgkmcnt(6)
    buffer_store_dwordx4 v[16:19], v11, s[8:11], s42 offen sc1
    v_dot2c_f32_bf16 v100, s44, v16
    v_dot2c_f32_bf16 v100, s44, v17
    v_dot2c_f32_bf16 v100, s44, v18
    v_dot2c_f32_bf16 v100, s44, v19
    s_mul_i32 s42, s24, s39
    s_add_u32 s42, s42, s25
    s_add_u32 s42, s42, s35
    s_waitcnt lgkmcnt(4)
    buffer_store_dwordx4 v[20:23], v11, s[8:11], s42 offen sc1
    v_dot2c_f32_bf16 v101, s44, v20
    v_dot2c_f32_bf16 v101, s44, v21
    v_dot2c_f32_bf16 v101, s44, v22
    v_dot2c_f32_bf16 v101, s44, v23
    s_mul_i32 s42, s24, s40
    s_add_u32 s42, s42, s25
    s_add_u32 s42, s42, s36
    s_waitcnt lgkmcnt(2)
    buffer_store_dwordx4 v[24:27], v11, s[8:11], s42 offen sc1
    v_dot2c_f32_bf16 v102, s44, v24
    v_dot2c_f32_bf16 v102, s44, v25
    v_dot2c_f32_bf16 v102, s44, v26
    v_dot2c_f32_bf16 v102, s44, v27
    s_mul_i32 s42, s24, s41
    s_add_u32 s42, s42, s25
    s_add_u32 s42, s42, s37
    s_waitcnt lgkmcnt(0)
    buffer_store_dwordx4 v[28:31], v11, s[8:11], s42 offen sc1
    v_dot2c_f32_bf16 v103, s44, v28
    v_dot2c_f32_bf16 v103, s44, v29
    v_dot2c_f32_bf16 v103, s44, v30
    v_dot2c_f32_bf16 v103, s44, v31
    v_mov_b32 v104, v100
    v_mov_b32 v105, v101
    v_mov_b32 v106, v102
    v_mov_b32 v107, v103
    v_permlane32_swap_b32 v100, v104
    v_permlane32_swap_b32 v101, v105
    v_permlane32_swap_b32 v102, v106
    v_permlane32_swap_b32 v103, v107
    s_mov_b32 vcc_lo, 0
    s_mov_b32 vcc_hi, -1
    v_add_f32 v100, v100, v104
    v_cvt_pk_bf16_f32 v104, v100, v100
    v_and_b32 v104, s59, v104
    v_sub_f32 v104, v100, v104
    v_cndmask_b32 v100, v100, v104, vcc
    v_cvt_pk_bf16_f32 v100, v100, v100
    ds_write_b16 v5, v100 offset:0
    v_add_f32 v101, v101, v105
    v_cvt_pk_bf16_f32 v105, v101, v101
    v_and_b32 v105, s59, v105
    v_sub_f32 v105, v101, v105
    v_cndmask_b32 v101, v101, v105, vcc
    v_cvt_pk_bf16_f32 v101, v101, v101
    ds_write_b16 v5, v101 offset:128
    v_add_f32 v102, v102, v106
    v_cvt_pk_bf16_f32 v106, v102, v102
    v_and_b32 v106, s59, v106
    v_sub_f32 v106, v102, v106
    v_cndmask_b32 v102, v102, v106, vcc
    v_cvt_pk_bf16_f32 v102, v102, v102
    ds_write_b16 v5, v102 offset:256
    v_add_f32 v103, v103, v107
    v_cvt_pk_bf16_f32 v107, v103, v103
    v_and_b32 v107, s59, v107
    v_sub_f32 v107, v103, v107
    v_cndmask_b32 v103, v103, v107, vcc
    v_cvt_pk_bf16_f32 v103, v103, v103
    ds_write_b16 v5, v103 offset:384
    s_mov_b64 exec, 0xff
    ds_read_b128 v[104:107], v10 offset:0
    ds_read_b128 v[108:111], v10 offset:128
    ds_read_b128 v[112:115], v10 offset:256
    ds_read_b128 v[116:119], v10 offset:384
    s_waitcnt lgkmcnt(3)
    buffer_store_dwordx4 v[104:107], v4, s[8:11], s28 offen sc1
    s_waitcnt lgkmcnt(2)
    buffer_store_dwordx4 v[108:111], v4, s[8:11], s29 offen sc1
    s_waitcnt lgkmcnt(1)
    buffer_store_dwordx4 v[112:115], v4, s[8:11], s30 offen sc1
    s_waitcnt lgkmcnt(0)
    buffer_store_dwordx4 v[116:119], v4, s[8:11], s31 offen sc1
    s_mov_b64 exec, -1
L_w1_done:
    buffer_load_dword v123, v122, s[52:55], 0 offen sc1
    s_lshl_b32 s56, s43, 4
    s_add_u32 s56, s56, s7
    s_mul_i32 s56, s56, 128
    s_add_u32 s56, s56, 22372352
    s_lshr_b32 s34, s5, 2
    s_lshl_b32 s34, s34, 2
    s_lshr_b32 s34, 19088743, s34
    s_and_b32 s34, s34, 7
    s_and_b32 s35, s5, 3
    s_and_b32 s36, s4, 1
    s_lshr_b32 s37, s4, 1
    s_lshl_b32 s96, s34, 1
    s_add_u32 s96, s96, s36
    s_lshl_b32 s97, s37, 2
    s_add_u32 s97, s97, s35
    s_lshl_b32 s98, s96, 1
    s_and_b32 s36, s37, 1
    s_add_u32 s98, s98, s36
    s_and_b32 s99, s4, 4
    s_add_u32 s99, s99, s35
    s_mul_i32 s92, s97, 294912
    s_lshl_b32 s93, s33, 12
    s_add_u32 s92, s92, s93
    s_add_u32 s92, s92, 7929856
    s_mul_i32 s95, s99, 56
    s_mul_i32 s35, s33, 14
    s_add_u32 s95, s95, s35
    s_mul_i32 s95, s95, 5120
    s_add_u32 s95, s95, 12648448
    s_lshl_b32 s13, s96, 2
    s_add_u32 s13, s13, s33
    s_mul_i32 s16, s13, 40960
    s_add_u32 s16, s16, 5242880
    s_mul_i32 s17, s13, 114688
    s_lshr_b32 s12, s97, 2
    s_mul_i32 s12, s12, 14336
    s_add_u32 s17, s17, s12
    s_and_b32 s12, s97, 3
    s_lshl_b32 s12, s12, 9
    s_add_u32 s17, s17, s12
    s_add_u32 s17, s17, 14942208
    s_mul_i32 s19, s13, 512
    s_add_u32 s19, s19, 22413312
    s_mul_i32 s20, s96, 2048
    s_mul_i32 s18, s97, 128
    s_add_u32 s18, s18, s20
    s_add_u32 s18, s18, 22413312
    s_add_u32 s20, s20, 22511616
    s_cmp_eq_u32 s33, 0
    s_cselect_b32 s18, s18, 0x70000000
    s_lshl_b32 s13, s98, 2
    s_add_u32 s13, s13, s33
    s_mul_i32 s28, s13, 20480
    s_mul_i32 s12, s99, 160
    s_add_u32 s28, s28, s12
    s_mul_i32 s25, s13, 57344
    s_add_u32 s25, s25, 14954496
    s_lshr_b32 s26, s13, 1
    s_mul_i32 s26, s26, 40960
    s_and_b32 s12, s33, 1
    s_lshl_b32 s12, s12, 3
    s_add_u32 s26, s26, s12
    s_mul_i32 s12, s99, 5120
    s_add_u32 s26, s26, s12
    s_add_u32 s26, s26, 5242880
    s_add_u32 s27, s26, 4096
    s_sub_u32 s29, s96, 10
    s_cmp_lt_u32 s96, 12
    s_cselect_b32 s29, 1, s29
    s_cmp_lt_u32 s96, 8
    s_cselect_b32 s29, 0, s29
    s_mul_i32 s29, s29, 20480
    s_add_u32 s29, s29, 22544384
    s_cmp_lt_u32 s96, 12
    s_cselect_b32 s14, s29, 22544384
    s_cselect_b32 s15, 1, 0
    s_mov_b32 s3, s16
    s_mul_i32 s30, s33, 10240
    s_add_u32 s31, s95, 61440
    s_mul_i32 s13, s98, 229376
    s_mul_i32 s12, s33, 14336
    s_add_u32 s13, s13, s12
    s_add_u32 s13, s13, 14942208
    s_add_u32 s12, s33, 1
    s_and_b32 s12, s12, 3
    s_mul_i32 s21, s12, 57344
    s_add_u32 s21, s21, s13
    s_add_u32 s12, s33, 2
    s_and_b32 s12, s12, 3
    s_mul_i32 s22, s12, 57344
    s_add_u32 s22, s22, s13
    s_add_u32 s12, s33, 3
    s_and_b32 s12, s12, 3
    s_mul_i32 s23, s12, 57344
    s_add_u32 s23, s23, s13
    s_add_u32 s12, s33, 4
    s_and_b32 s12, s12, 3
    s_mul_i32 s24, s12, 57344
    s_add_u32 s24, s24, s13
    s_movk_i32 s13, 4
    v_min_u32 v8, 11, v0
    v_mul_u32_u24 v8, 128, v8
    s_lshr_b32 s57, s97, 1
    s_mul_i32 s57, s57, 2048
    s_add_u32 s57, s57, 22372352
    s_lshl_b32 s39, s33, 6
    v_add_u32 v142, s39, v0
    v_min_u32 v142, 159, v142
    v_mul_u32_u24 v142, 128, v142
    v_lshlrev_b32 v1, 4, v0
    v_mul_u32_u24 v13, 128, v0
    s_mov_b32 s47, 22364160
    v_mov_b32 v252, 0x80000000
    v_mov_b32 v253, 1
    v_writelane_b32 v252, 0, 0
    s_mov_b32 s41, 0x70000000
    s_waitcnt vmcnt(0)
    v_cmp_gt_u32 vcc, 1, v123
    s_nop 0
    s_cbranch_vccnz L_go_b_slow
L_go_b_ok:
    s_waitcnt vmcnt(0)
    s_barrier
    s_cmp_eq_u32 s33, 0
    s_cselect_b32 s42, s56, 0x7f000000
    buffer_store_dword v7, v6, s[8:11], s42 offen sc1
    v_add_u32 v4, 0x10000, v1
    v_add_u32 v5, 0x20000, v1
    v_bfe_u32 v2, v0, 4, 1
    v_mul_u32_u24 v2, 57344, v2
    v_lshrrev_b32 v236, 5, v0
    v_lshl_add_u32 v2, v236, 8, v2
    v_lshrrev_b32 v3, 2, v0
    v_lshlrev_b32 v3, 6, v3
    v_and_b32 v7, 3, v0
    v_lshl_add_u32 v3, v7, 3, v3
    v_and_b32 v7, 15, v0
    v_lshlrev_b32 v7, 4, v7
    v_add_u32 v2, v2, v7
    v_lshrrev_b32 v236, 4, v0
    v_lshl_add_u32 v6, v236, 9, v7
    v_lshl_add_u32 v7, v236, 8, v7
    v_and_b32 v254, 3, v0
    v_mul_u32_u24 v254, 128, v254
    s_mul_i32 s58, s33, 28
    s_add_u32 s58, s58, 0
    v_min_u32 v10, 27, v0
    v_add_u32 v10, s58, v10
    v_mul_u32_u24 v10, 128, v10
    s_mov_b32 s58, 22388736
    s_cmp_lt_u32 s5, 28
    s_cbranch_scc1 L_nocan
    s_cmp_lg_u32 s33, 0
    s_cbranch_scc1 L_fx2_ok
    s_add_u32 s46, s4, 7
    s_and_b32 s46, s46, 7
    s_mul_i32 s46, s46, 2048
    s_add_u32 s46, s46, 22388736
    v_and_b32 v15, 0, v0
    v_mul_u32_u24 v15, 128, v15
    buffer_load_dword v11, v15, s[8:11], s46 offen sc1
    s_waitcnt vmcnt(0)
    v_cmp_gt_u32 vcc, 1, v11
    s_nop 0
    s_cbranch_vccnz L_can_slow
L_can_ok:
    buffer_load_dword v14, v13, s[8:11], s47 offen sc1
    s_waitcnt vmcnt(0)
    v_cmp_gt_u32 vcc, 1, v14
    s_nop 0
    s_cbranch_vccnz L_fx2_slow
L_fx2_ok:
    s_barrier
L_nocan:
    s_cmp_eq_u32 s33, 0
    s_cselect_b32 s47, s47, 0x70000000
    buffer_load_dword v11, v10, s[8:11], s58 offen sc1
    buffer_load_dword v14, v13, s[8:11], s47 offen sc1
    s_waitcnt vmcnt(1)
    v_cmp_gt_u32 vcc, 1, v11
    s_nop 0
    s_cbranch_vccnz L_fd_s_slow
L_fd_s_ok:
    buffer_load_dwordx4 a[40:43], v1, s[8:11], s95 offen offset:0 sc1
    buffer_load_dwordx4 a[44:47], v1, s[8:11], s95 offen offset:1024 sc1
    buffer_load_dwordx4 a[48:51], v1, s[8:11], s95 offen offset:2048 sc1
    buffer_load_dwordx4 a[52:55], v1, s[8:11], s95 offen offset:3072 sc1
    s_addk_i32 s95, 4096
    buffer_load_dwordx4 a[56:59], v1, s[8:11], s95 offen offset:0 sc1
    buffer_load_dwordx4 a[60:63], v1, s[8:11], s95 offen offset:1024 sc1
    buffer_load_dwordx4 a[64:67], v1, s[8:11], s95 offen offset:2048 sc1
    buffer_load_dwordx4 a[68:71], v1, s[8:11], s95 offen offset:3072 sc1
    s_addk_i32 s95, 4096
    buffer_load_dwordx4 a[72:75], v1, s[8:11], s95 offen offset:0 sc1
    buffer_load_dwordx4 a[76:79], v1, s[8:11], s95 offen offset:1024 sc1
    buffer_load_dwordx4 a[80:83], v1, s[8:11], s95 offen offset:2048 sc1
    buffer_load_dwordx4 a[84:87], v1, s[8:11], s95 offen offset:3072 sc1
    s_addk_i32 s95, 4096
    buffer_load_dwordx4 a[88:91], v1, s[8:11], s95 offen offset:0 sc1
    buffer_load_dwordx4 a[92:95], v1, s[8:11], s95 offen offset:1024 sc1
    buffer_load_dwordx4 a[96:99], v1, s[8:11], s95 offen offset:2048 sc1
    buffer_load_dwordx4 a[100:103], v1, s[8:11], s95 offen offset:3072 sc1
    s_addk_i32 s95, 4096
    buffer_load_dwordx4 a[104:107], v1, s[8:11], s95 offen offset:0 sc1
    buffer_load_dwordx4 a[108:111], v1, s[8:11], s95 offen offset:1024 sc1
    buffer_load_dwordx4 a[112:115], v1, s[8:11], s95 offen offset:2048 sc1
    buffer_load_dwordx4 a[116:119], v1, s[8:11], s95 offen offset:3072 sc1
    s_addk_i32 s95, 4096
    buffer_load_dwordx4 a[120:123], v1, s[8:11], s95 offen offset:0 sc1
    buffer_load_dwordx4 a[124:127], v1, s[8:11], s95 offen offset:1024 sc1
    buffer_load_dwordx4 a[128:131], v1, s[8:11], s95 offen offset:2048 sc1
    buffer_load_dwordx4 a[132:135], v1, s[8:11], s95 offen offset:3072 sc1
    s_cmp_lg_u32 s33, 0
    s_cbranch_scc1 L_fw_s_ok
    s_waitcnt vmcnt(24)
    v_cmp_gt_u32 vcc, 1, v14
    s_nop 0
    s_cbranch_vccnz L_fx_s_slow
L_fx_s_ok:
    s_cmp_lt_u32 s5, 28
    s_cbranch_scc1 L_can2_ok
    s_add_u32 s46, s4, 7
    s_and_b32 s46, s46, 7
    s_mul_i32 s46, s46, 2048
    s_add_u32 s46, s46, 22544384
    v_mov_b32 v15, 0
    buffer_load_dword v11, v15, s[8:11], s46 offen sc1
    s_waitcnt vmcnt(0)
    v_cmp_gt_u32 vcc, 1, v11
    s_nop 0
    s_cbranch_vccnz L_can2_slow
L_can2_ok:
    buffer_load_dword v9, v8, s[8:11], s57 offen sc1
    s_waitcnt vmcnt(0)
    v_cmp_gt_u32 vcc, 1, v9
    s_nop 0
    s_cbranch_vccnz L_fw_s_slow
L_fw_s_ok:
    s_barrier
    s_add_u32 m0, s93, 0
    s_add_u32 s94, s92, 0
    buffer_load_dwordx4 v1, s[8:11], s94 offen offset:0 sc1 lds
    buffer_load_dwordx4 v1, s[8:11], s94 offen offset:1024 sc1 lds
    buffer_load_dwordx4 v1, s[8:11], s94 offen offset:2048 sc1 lds
    buffer_load_dwordx4 v1, s[8:11], s94 offen offset:3072 sc1 lds
    s_add_u32 m0, s93, 16384
    s_add_u32 s94, s92, 16384
    buffer_load_dwordx4 v1, s[8:11], s94 offen offset:0 sc1 lds
    buffer_load_dwordx4 v1, s[8:11], s94 offen offset:1024 sc1 lds
    buffer_load_dwordx4 v1, s[8:11], s94 offen offset:2048 sc1 lds
    buffer_load_dwordx4 v1, s[8:11], s94 offen offset:3072 sc1 lds
L_ring:
    s_add_u32 m0, s93, 32768
    s_add_u32 s94, s92, 32768
    buffer_load_dwordx4 v1, s[8:11], s94 offen offset:0 sc1 lds
    buffer_load_dwordx4 v1, s[8:11], s94 offen offset:1024 sc1 lds
    buffer_load_dwordx4 v1, s[8:11], s94 offen offset:2048 sc1 lds
    buffer_load_dwordx4 v1, s[8:11], s94 offen offset:3072 sc1 lds
    s_add_u32 m0, s93, 49152
    s_add_u32 s94, s92, 49152
    buffer_load_dwordx4 v1, s[8:11], s94 offen offset:0 sc1 lds
    buffer_load_dwordx4 v1, s[8:11], s94 offen offset:1024 sc1 lds
    buffer_load_dwordx4 v1, s[8:11], s94 offen offset:2048 sc1 lds
    buffer_load_dwordx4 v1, s[8:11], s94 offen offset:3072 sc1 lds
    s_add_u32 m0, s93, 65536
    s_add_u32 s94, s92, 65536
    buffer_load_dwordx4 v1, s[8:11], s94 offen offset:0 sc1 lds
    buffer_load_dwordx4 v1, s[8:11], s94 offen offset:1024 sc1 lds
    buffer_load_dwordx4 v1, s[8:11], s94 offen offset:2048 sc1 lds
    buffer_load_dwordx4 v1, s[8:11], s94 offen offset:3072 sc1 lds
    s_barrier
    buffer_load_dword v11, v142, s[8:11], s14 offen sc1
    s_add_u32 m0, s93, 81920
    s_add_u32 s94, s92, 81920
    buffer_load_dwordx4 v1, s[8:11], s94 offen offset:0 sc1 lds
    buffer_load_dwordx4 v1, s[8:11], s94 offen offset:1024 sc1 lds
    buffer_load_dwordx4 v1, s[8:11], s94 offen offset:2048 sc1 lds
    buffer_load_dwordx4 v1, s[8:11], s94 offen offset:3072 sc1 lds
    s_waitcnt vmcnt(4)
    v_cmp_gt_u32 vcc, 1, v11
    s_nop 0
    s_cbranch_vccnz L_s2_slow
L_s2_ok:
    buffer_store_dword v253, v252, s[8:11], s41 offen sc1
    s_barrier
    buffer_load_dwordx4 v[8:11], v6, s[8:11], s16 offen offset:0 sc1
    buffer_load_dwordx4 v[12:15], v6, s[8:11], s16 offen offset:256 sc1
    buffer_load_dwordx4 v[16:19], v6, s[8:11], s16 offen offset:2048 sc1
    buffer_load_dwordx4 v[20:23], v6, s[8:11], s16 offen offset:2304 sc1
    s_addk_i32 s16, 4096
    buffer_load_dwordx4 v[24:27], v6, s[8:11], s16 offen offset:0 sc1
    buffer_load_dwordx4 v[28:31], v6, s[8:11], s16 offen offset:256 sc1
    buffer_load_dwordx4 v[32:35], v6, s[8:11], s16 offen offset:2048 sc1
    buffer_load_dwordx4 v[36:39], v6, s[8:11], s16 offen offset:2304 sc1
    s_addk_i32 s16, 4096
    buffer_load_dwordx4 v[40:43], v6, s[8:11], s16 offen offset:0 sc1
    buffer_load_dwordx4 v[44:47], v6, s[8:11], s16 offen offset:256 sc1
    buffer_load_dwordx4 v[48:51], v6, s[8:11], s16 offen offset:2048 sc1
    buffer_load_dwordx4 v[52:55], v6, s[8:11], s16 offen offset:2304 sc1
    s_addk_i32 s16, 4096
    buffer_load_dwordx4 v[56:59], v6, s[8:11], s16 offen offset:0 sc1
    buffer_load_dwordx4 v[60:63], v6, s[8:11], s16 offen offset:256 sc1
    ds_read_b128 a[0:3], v1 offset:0
    ds_read_b128 a[4:7], v1 offset:4096
    ds_read_b128 a[8:11], v1 offset:1024
    ds_read_b128 a[12:15], v1 offset:5120
    ds_read_b128 a[16:19], v1 offset:2048
    ds_read_b128 a[20:23], v1 offset:6144
    ds_read_b128 a[24:27], v1 offset:3072
    ds_read_b128 a[28:31], v1 offset:7168
    ds_read_b128 a[32:35], v1 offset:8192
    ds_read_b128 a[36:39], v1 offset:12288
    s_waitcnt vmcnt(10)
    v_swap_b32 v10, v12
    v_swap_b32 v11, v13
    v_swap_b32 v18, v20
    v_swap_b32 v19, v21
    v_mfma_f32_16x16x32_bf16 v[204:207], v[8:11], v[8:11], 0
    buffer_load_dwordx4 v[64:67], v6, s[8:11], s16 offen offset:2048 sc1
    v_mfma_f32_16x16x32_bf16 v[204:207], v[16:19], v[16:19], v[204:207]
    buffer_load_dwordx4 v[68:71], v6, s[8:11], s16 offen offset:2304 sc1
    v_mfma_f32_16x16x32_bf16 v[208:211], v[12:15], v[12:15], 0
    s_waitcnt lgkmcnt(6)
    s_addk_i32 s16, 4096
    v_mfma_f32_16x16x32_bf16 v[208:211], v[20:23], v[20:23], v[208:211]
    s_nop 7
    v_cmp_u_f32 vcc, v204, v208
    s_nop 0
    s_cbranch_vccnz L_hv0
L_hok0:
    v_mfma_f32_16x16x32_bf16 v[172:175], a[0:3], v[8:11], 0
    s_waitcnt vmcnt(8)
    v_mfma_f32_16x16x32_bf16 v[172:175], a[4:7], v[16:19], v[172:175]
    v_swap_b32 v26, v28
    v_mfma_f32_16x16x32_bf16 v[176:179], a[4:7], v[20:23], 0
    buffer_load_dwordx4 v[72:75], v6, s[8:11], s16 offen offset:0 sc1
    v_mfma_f32_16x16x32_bf16 v[176:179], a[0:3], v[12:15], v[176:179]
    v_swap_b32 v27, v29
    v_mfma_f32_16x16x32_bf16 v[184:187], a[8:11], v[12:15], 0
    ds_read_b128 a[0:3], v1 offset:9216
    v_mfma_f32_16x16x32_bf16 v[184:187], a[12:15], v[20:23], v[184:187]
    v_swap_b32 v34, v36
    v_mfma_f32_16x16x32_bf16 v[180:183], a[12:15], v[16:19], 0
    ds_read_b128 a[4:7], v1 offset:13312
    v_swap_b32 v35, v37
    v_mfma_f32_16x16x32_bf16 v[180:183], a[8:11], v[8:11], v[180:183]
    buffer_load_dwordx4 v[76:79], v6, s[8:11], s16 offen offset:256 sc1
    v_mfma_f32_16x16x32_bf16 v[212:215], v[24:27], v[24:27], v[204:207]
    ds_read_b128 a[8:11], v1 offset:10240
    v_mfma_f32_16x16x32_bf16 v[212:215], v[32:35], v[32:35], v[212:215]
    buffer_load_dwordx4 v[80:83], v6, s[8:11], s16 offen offset:2048 sc1
    v_mfma_f32_16x16x32_bf16 v[216:219], v[28:31], v[28:31], v[208:211]
    ds_read_b128 a[12:15], v1 offset:14336
    s_waitcnt lgkmcnt(6)
    v_mfma_f32_16x16x32_bf16 v[216:219], v[36:39], v[36:39], v[216:219]
    buffer_load_dwordx4 v[84:87], v6, s[8:11], s16 offen offset:2304 sc1
    v_mfma_f32_16x16x32_bf16 v[188:191], a[16:19], v[8:11], 0
    v_mfma_f32_16x16x32_bf16 v[188:191], a[20:23], v[16:19], v[188:191]
    s_waitcnt vmcnt(8)
    s_addk_i32 s16, 4096
    v_mfma_f32_16x16x32_bf16 v[192:195], a[20:23], v[20:23], 0
    v_swap_b32 v42, v44
    v_mfma_f32_16x16x32_bf16 v[192:195], a[16:19], v[12:15], v[192:195]
    buffer_load_dwordx4 v[88:91], v6, s[8:11], s16 offen offset:0 sc1
    v_mfma_f32_16x16x32_bf16 v[200:203], a[24:27], v[12:15], 0
    ds_read_b128 a[16:19], v1 offset:11264
    v_cmp_u_f32 vcc, v212, v216
    v_mfma_f32_16x16x32_bf16 v[200:203], a[28:31], v[20:23], v[200:203]
    v_swap_b32 v43, v45
    v_mfma_f32_16x16x32_bf16 v[196:199], a[28:31], v[16:19], 0
    ds_read_b128 a[20:23], v1 offset:15360
    s_waitcnt lgkmcnt(4)
    v_mfma_f32_16x16x32_bf16 v[196:199], a[24:27], v[8:11], v[196:199]
    s_cbranch_vccnz L_hv1
L_hok1:
    v_mov_b32 v238, 0
    v_mfma_f32_16x16x32_bf16 v[172:175], a[32:35], v[24:27], v[172:175]
    ds_read_b128 a[24:27], v1 offset:16384
    v_mov_b32 v239, 0
    v_mfma_f32_16x16x32_bf16 v[172:175], a[36:39], v[32:35], v[172:175]
    v_swap_b32 v50, v52
    v_mfma_f32_16x16x32_bf16 v[176:179], a[36:39], v[36:39], v[176:179]
    ds_read_b128 a[28:31], v1 offset:20480
    s_mov_b32 s42, 1048577
    v_mfma_f32_16x16x32_bf16 v[176:179], a[32:35], v[28:31], v[176:179]
    buffer_load_dwordx4 v[92:95], v6, s[8:11], s16 offen offset:256 sc1
    v_mfma_f32_16x16x32_bf16 v[184:187], a[0:3], v[28:31], v[184:187]
    ds_read_b128 a[32:35], v1 offset:17408
    s_mov_b32 s43, 268435712
    v_mfma_f32_16x16x32_bf16 v[184:187], a[4:7], v[36:39], v[184:187]
    v_swap_b32 v51, v53
    v_mfma_f32_16x16x32_bf16 v[180:183], a[4:7], v[32:35], v[180:183]
    ds_read_b128 a[36:39], v1 offset:21504
    s_mov_b32 s44, 2097154
    v_mfma_f32_16x16x32_bf16 v[180:183], a[0:3], v[24:27], v[180:183]
    buffer_load_dwordx4 v[96:99], v6, s[8:11], s16 offen offset:2048 sc1
    v_mfma_f32_16x16x32_bf16 v[204:207], v[40:43], v[40:43], v[212:215]
    ds_read_b128 a[0:3], v1 offset:18432
    s_mov_b32 s45, 536871424
    v_mfma_f32_16x16x32_bf16 v[204:207], v[48:51], v[48:51], v[204:207]
    buffer_load_dwordx4 v[100:103], v6, s[8:11], s16 offen offset:2304 sc1
    v_mfma_f32_16x16x32_bf16 v[208:211], v[44:47], v[44:47], v[216:219]
    ds_read_b128 a[4:7], v1 offset:22528
    s_waitcnt lgkmcnt(6)
    s_addk_i32 s16, 4096
    v_mfma_f32_16x16x32_bf16 v[208:211], v[52:55], v[52:55], v[208:211]
    buffer_load_dwordx4 v[104:107], v6, s[8:11], s16 offen offset:0 sc1
    v_mfma_f32_16x16x32_bf16 v[188:191], a[8:11], v[24:27], v[188:191]
    s_mov_b32 s46, 4194308
    s_mov_b32 s47, 1073742848
    v_mfma_f32_16x16x32_bf16 v[188:191], a[12:15], v[32:35], v[188:191]
    s_waitcnt vmcnt(9)
    s_mov_b32 s36, 8388616
    v_mfma_f32_16x16x32_bf16 v[192:195], a[12:15], v[36:39], v[192:195]
    v_swap_b32 v58, v60
    v_mfma_f32_16x16x32_bf16 v[192:195], a[8:11], v[28:31], v[192:195]
    buffer_load_dwordx4 v[108:111], v6, s[8:11], s16 offen offset:256 sc1
    v_mfma_f32_16x16x32_bf16 v[200:203], a[16:19], v[28:31], v[200:203]
    ds_read_b128 a[8:11], v1 offset:19456
    v_cmp_u_f32 vcc, v204, v208
    v_mfma_f32_16x16x32_bf16 v[200:203], a[20:23], v[36:39], v[200:203]
    v_swap_b32 v59, v61
    v_mfma_f32_16x16x32_bf16 v[196:199], a[20:23], v[32:35], v[196:199]
    ds_read_b128 a[12:15], v1 offset:23552
    s_waitcnt lgkmcnt(4)
    v_mfma_f32_16x16x32_bf16 v[196:199], a[16:19], v[24:27], v[196:199]
    s_cbranch_vccnz L_hv2
L_hok2:
    s_mov_b32 s37, 2147485696
    v_mfma_f32_16x16x32_bf16 v[172:175], a[24:27], v[40:43], v[172:175]
    ds_read_b128 a[16:19], v1 offset:24576
    v_mfma_f32_16x16x32_bf16 v[172:175], a[28:31], v[48:51], v[172:175]
    v_swap_b32 v66, v68
    v_mfma_f32_16x16x32_bf16 v[176:179], a[28:31], v[52:55], v[176:179]
    ds_read_b128 a[20:23], v1 offset:28672
    v_mfma_f32_16x16x32_bf16 v[176:179], a[24:27], v[44:47], v[176:179]
    buffer_load_dwordx4 v[112:115], v6, s[8:11], s16 offen offset:2048 sc1
    v_mfma_f32_16x16x32_bf16 v[184:187], a[32:35], v[44:47], v[184:187]
    ds_read_b128 a[24:27], v1 offset:25600
    v_mfma_f32_16x16x32_bf16 v[184:187], a[36:39], v[52:55], v[184:187]
    v_swap_b32 v67, v69
    v_mfma_f32_16x16x32_bf16 v[180:183], a[36:39], v[48:51], v[180:183]
    ds_read_b128 a[28:31], v1 offset:29696
    v_mfma_f32_16x16x32_bf16 v[180:183], a[32:35], v[40:43], v[180:183]
    buffer_load_dwordx4 v[116:119], v6, s[8:11], s16 offen offset:2304 sc1
    v_mfma_f32_16x16x32_bf16 v[212:215], v[56:59], v[56:59], v[204:207]
    ds_read_b128 a[32:35], v1 offset:26624
    s_addk_i32 s16, 4096
    v_mfma_f32_16x16x32_bf16 v[212:215], v[64:67], v[64:67], v[212:215]
    buffer_load_dwordx4 v[120:123], v6, s[8:11], s16 offen offset:0 sc1
    v_mfma_f32_16x16x32_bf16 v[216:219], v[60:63], v[60:63], v[208:211]
    ds_read_b128 a[36:39], v1 offset:30720
    s_waitcnt lgkmcnt(6)
    v_mfma_f32_16x16x32_bf16 v[216:219], v[68:71], v[68:71], v[216:219]
    buffer_load_dwordx4 v[124:127], v6, s[8:11], s16 offen offset:256 sc1
    v_mfma_f32_16x16x32_bf16 v[188:191], a[0:3], v[40:43], v[188:191]
    v_mfma_f32_16x16x32_bf16 v[188:191], a[4:7], v[48:51], v[188:191]
    s_waitcnt vmcnt(10)
    v_mfma_f32_16x16x32_bf16 v[192:195], a[4:7], v[52:55], v[192:195]
    v_swap_b32 v74, v76
    v_mfma_f32_16x16x32_bf16 v[192:195], a[0:3], v[44:47], v[192:195]
    buffer_load_dwordx4 v[128:131], v6, s[8:11], s16 offen offset:2048 sc1
    v_mfma_f32_16x16x32_bf16 v[200:203], a[8:11], v[44:47], v[200:203]
    ds_read_b128 a[0:3], v1 offset:27648
    v_cmp_u_f32 vcc, v212, v216
    v_mfma_f32_16x16x32_bf16 v[200:203], a[12:15], v[52:55], v[200:203]
    v_swap_b32 v75, v77
    v_mfma_f32_16x16x32_bf16 v[196:199], a[12:15], v[48:51], v[196:199]
    ds_read_b128 a[4:7], v1 offset:31744
    s_waitcnt lgkmcnt(4)
    v_mfma_f32_16x16x32_bf16 v[196:199], a[8:11], v[40:43], v[196:199]
    s_cbranch_vccnz L_hv3
L_hok3:
    v_mfma_f32_16x16x32_bf16 v[172:175], a[16:19], v[56:59], v[172:175]
    ds_read_b128 a[8:11], v1 offset:32768
    v_mfma_f32_16x16x32_bf16 v[172:175], a[20:23], v[64:67], v[172:175]
    v_swap_b32 v82, v84
    v_mfma_f32_16x16x32_bf16 v[176:179], a[20:23], v[68:71], v[176:179]
    ds_read_b128 a[12:15], v1 offset:36864
    v_mfma_f32_16x16x32_bf16 v[176:179], a[16:19], v[60:63], v[176:179]
    buffer_load_dwordx4 v[132:135], v6, s[8:11], s16 offen offset:2304 sc1
    v_mfma_f32_16x16x32_bf16 v[184:187], a[24:27], v[60:63], v[184:187]
    ds_read_b128 a[16:19], v1 offset:33792
    s_addk_i32 s16, 4096
    v_mfma_f32_16x16x32_bf16 v[184:187], a[28:31], v[68:71], v[184:187]
    v_swap_b32 v83, v85
    v_mfma_f32_16x16x32_bf16 v[180:183], a[28:31], v[64:67], v[180:183]
    ds_read_b128 a[20:23], v1 offset:37888
    v_mfma_f32_16x16x32_bf16 v[180:183], a[24:27], v[56:59], v[180:183]
    buffer_load_dwordx4 v[136:139], v6, s[8:11], s16 offen offset:0 sc1
    v_mfma_f32_16x16x32_bf16 v[204:207], v[72:75], v[72:75], v[212:215]
    ds_read_b128 a[24:27], v1 offset:34816
    v_mfma_f32_16x16x32_bf16 v[204:207], v[80:83], v[80:83], v[204:207]
    buffer_load_dwordx4 v[140:143], v6, s[8:11], s16 offen offset:256 sc1
    v_mfma_f32_16x16x32_bf16 v[208:211], v[76:79], v[76:79], v[216:219]
    ds_read_b128 a[28:31], v1 offset:38912
    s_waitcnt lgkmcnt(6)
    v_mfma_f32_16x16x32_bf16 v[208:211], v[84:87], v[84:87], v[208:211]
    buffer_load_dwordx4 v[144:147], v6, s[8:11], s16 offen offset:2048 sc1
    v_mfma_f32_16x16x32_bf16 v[188:191], a[32:35], v[56:59], v[188:191]
    v_mfma_f32_16x16x32_bf16 v[188:191], a[36:39], v[64:67], v[188:191]
    s_waitcnt vmcnt(11)
    v_mfma_f32_16x16x32_bf16 v[192:195], a[36:39], v[68:71], v[192:195]
    v_swap_b32 v90, v92
    v_mfma_f32_16x16x32_bf16 v[192:195], a[32:35], v[60:63], v[192:195]
    buffer_load_dwordx4 v[148:151], v6, s[8:11], s16 offen offset:2304 sc1
    v_mfma_f32_16x16x32_bf16 v[200:203], a[0:3], v[60:63], v[200:203]
    ds_read_b128 a[32:35], v1 offset:35840
    v_cmp_u_f32 vcc, v204, v208
    v_mfma_f32_16x16x32_bf16 v[200:203], a[4:7], v[68:71], v[200:203]
    v_swap_b32 v91, v93
    v_mfma_f32_16x16x32_bf16 v[196:199], a[4:7], v[64:67], v[196:199]
    ds_read_b128 a[36:39], v1 offset:39936
    s_waitcnt lgkmcnt(4)
    v_mfma_f32_16x16x32_bf16 v[196:199], a[0:3], v[56:59], v[196:199]
    s_cbranch_vccnz L_hv4
L_hok4:
    s_addk_i32 s16, 4096
    v_mfma_f32_16x16x32_bf16 v[172:175], a[8:11], v[72:75], v[172:175]
    ds_read_b128 a[0:3], v1 offset:40960
    v_mfma_f32_16x16x32_bf16 v[172:175], a[12:15], v[80:83], v[172:175]
    v_swap_b32 v98, v100
    v_mfma_f32_16x16x32_bf16 v[176:179], a[12:15], v[84:87], v[176:179]
    ds_read_b128 a[4:7], v1 offset:45056
    v_mfma_f32_16x16x32_bf16 v[176:179], a[8:11], v[76:79], v[176:179]
    buffer_load_dwordx4 v[152:155], v6, s[8:11], s16 offen offset:0 sc1
    v_mfma_f32_16x16x32_bf16 v[184:187], a[16:19], v[76:79], v[184:187]
    ds_read_b128 a[8:11], v1 offset:41984
    v_mfma_f32_16x16x32_bf16 v[184:187], a[20:23], v[84:87], v[184:187]
    v_swap_b32 v99, v101
    v_mfma_f32_16x16x32_bf16 v[180:183], a[20:23], v[80:83], v[180:183]
    ds_read_b128 a[12:15], v1 offset:46080
    v_mfma_f32_16x16x32_bf16 v[180:183], a[16:19], v[72:75], v[180:183]
    buffer_load_dwordx4 v[156:159], v6, s[8:11], s16 offen offset:256 sc1
    v_mfma_f32_16x16x32_bf16 v[212:215], v[88:91], v[88:91], v[204:207]
    ds_read_b128 a[16:19], v1 offset:43008
    v_mfma_f32_16x16x32_bf16 v[212:215], v[96:99], v[96:99], v[212:215]
    buffer_load_dwordx4 v[160:163], v6, s[8:11], s16 offen offset:2048 sc1
    v_mfma_f32_16x16x32_bf16 v[216:219], v[92:95], v[92:95], v[208:211]
    ds_read_b128 a[20:23], v1 offset:47104
    s_waitcnt lgkmcnt(6)
    v_mfma_f32_16x16x32_bf16 v[216:219], v[100:103], v[100:103], v[216:219]
    buffer_load_dwordx4 v[164:167], v6, s[8:11], s16 offen offset:2304 sc1
    v_mfma_f32_16x16x32_bf16 v[188:191], a[24:27], v[72:75], v[188:191]
    v_mfma_f32_16x16x32_bf16 v[188:191], a[28:31], v[80:83], v[188:191]
    s_waitcnt vmcnt(12)
    s_add_u32 m0, s93, 98304
    v_mfma_f32_16x16x32_bf16 v[192:195], a[28:31], v[84:87], v[192:195]
    v_swap_b32 v106, v108
    s_add_u32 s94, s92, 98304
    v_mfma_f32_16x16x32_bf16 v[192:195], a[24:27], v[76:79], v[192:195]
    buffer_load_dwordx4 v1, s[8:11], s94 offen offset:0 sc1 lds
    v_mfma_f32_16x16x32_bf16 v[200:203], a[32:35], v[76:79], v[200:203]
    ds_read_b128 a[24:27], v1 offset:44032
    v_cmp_u_f32 vcc, v212, v216
    v_mfma_f32_16x16x32_bf16 v[200:203], a[36:39], v[84:87], v[200:203]
    v_swap_b32 v107, v109
    v_mfma_f32_16x16x32_bf16 v[196:199], a[36:39], v[80:83], v[196:199]
    ds_read_b128 a[28:31], v1 offset:48128
    s_waitcnt lgkmcnt(4)
    v_mfma_f32_16x16x32_bf16 v[196:199], a[32:35], v[72:75], v[196:199]
    s_barrier
    s_cbranch_vccnz L_hv5
L_hok5:
    v_mfma_f32_16x16x32_bf16 v[172:175], a[0:3], v[88:91], v[172:175]
    ds_read_b128 a[32:35], v1 offset:49152
    v_mfma_f32_16x16x32_bf16 v[172:175], a[4:7], v[96:99], v[172:175]
    v_swap_b32 v114, v116
    v_mfma_f32_16x16x32_bf16 v[176:179], a[4:7], v[100:103], v[176:179]
    ds_read_b128 a[36:39], v1 offset:53248
    v_mfma_f32_16x16x32_bf16 v[176:179], a[0:3], v[92:95], v[176:179]
    buffer_load_dwordx4 v1, s[8:11], s94 offen offset:1024 sc1 lds
    v_mfma_f32_16x16x32_bf16 v[184:187], a[8:11], v[92:95], v[184:187]
    ds_read_b128 a[0:3], v1 offset:50176
    v_mfma_f32_16x16x32_bf16 v[184:187], a[12:15], v[100:103], v[184:187]
    v_swap_b32 v115, v117
    v_mfma_f32_16x16x32_bf16 v[180:183], a[12:15], v[96:99], v[180:183]
    ds_read_b128 a[4:7], v1 offset:54272
    v_mfma_f32_16x16x32_bf16 v[180:183], a[8:11], v[88:91], v[180:183]
    buffer_load_dwordx4 v1, s[8:11], s94 offen offset:2048 sc1 lds
    v_mfma_f32_16x16x32_bf16 v[204:207], v[104:107], v[104:107], v[212:215]
    ds_read_b128 a[8:11], v1 offset:51200
    v_mfma_f32_16x16x32_bf16 v[204:207], v[112:115], v[112:115], v[204:207]
    buffer_load_dwordx4 v1, s[8:11], s94 offen offset:3072 sc1 lds
    v_mfma_f32_16x16x32_bf16 v[208:211], v[108:111], v[108:111], v[216:219]
    ds_read_b128 a[12:15], v1 offset:55296
    s_waitcnt lgkmcnt(6)
    s_add_u32 m0, s93, 114688
    s_add_u32 s94, s92, 114688
    v_mfma_f32_16x16x32_bf16 v[208:211], v[116:119], v[116:119], v[208:211]
    buffer_load_dwordx4 v1, s[8:11], s94 offen offset:0 sc1 lds
    v_mfma_f32_16x16x32_bf16 v[188:191], a[16:19], v[88:91], v[188:191]
    v_mfma_f32_16x16x32_bf16 v[188:191], a[20:23], v[96:99], v[188:191]
    s_waitcnt vmcnt(13)
    v_mfma_f32_16x16x32_bf16 v[192:195], a[20:23], v[100:103], v[192:195]
    v_swap_b32 v122, v124
    v_mfma_f32_16x16x32_bf16 v[192:195], a[16:19], v[92:95], v[192:195]
    buffer_load_dwordx4 v1, s[8:11], s94 offen offset:1024 sc1 lds
    v_mfma_f32_16x16x32_bf16 v[200:203], a[24:27], v[92:95], v[200:203]
    ds_read_b128 a[16:19], v1 offset:52224
    v_cmp_u_f32 vcc, v204, v208
    v_mfma_f32_16x16x32_bf16 v[200:203], a[28:31], v[100:103], v[200:203]
    v_swap_b32 v123, v125
    v_mfma_f32_16x16x32_bf16 v[196:199], a[28:31], v[96:99], v[196:199]
    ds_read_b128 a[20:23], v1 offset:56320
    s_waitcnt lgkmcnt(4)
    v_mfma_f32_16x16x32_bf16 v[196:199], a[24:27], v[88:91], v[196:199]
    s_cbranch_vccnz L_hv6
L_hok6:
    v_mfma_f32_16x16x32_bf16 v[172:175], a[32:35], v[104:107], v[172:175]
    ds_read_b128 a[24:27], v1 offset:57344
    v_mfma_f32_16x16x32_bf16 v[172:175], a[36:39], v[112:115], v[172:175]
    v_swap_b32 v130, v132
    v_mfma_f32_16x16x32_bf16 v[176:179], a[36:39], v[116:119], v[176:179]
    ds_read_b128 a[28:31], v1 offset:61440
    v_mfma_f32_16x16x32_bf16 v[176:179], a[32:35], v[108:111], v[176:179]
    buffer_load_dwordx4 v1, s[8:11], s94 offen offset:2048 sc1 lds
    v_mfma_f32_16x16x32_bf16 v[184:187], a[0:3], v[108:111], v[184:187]
    ds_read_b128 a[32:35], v1 offset:58368
    v_mfma_f32_16x16x32_bf16 v[184:187], a[4:7], v[116:119], v[184:187]
    v_swap_b32 v131, v133
    v_mfma_f32_16x16x32_bf16 v[180:183], a[4:7], v[112:115], v[180:183]
    ds_read_b128 a[36:39], v1 offset:62464
    v_mfma_f32_16x16x32_bf16 v[180:183], a[0:3], v[104:107], v[180:183]
    buffer_load_dwordx4 v1, s[8:11], s94 offen offset:3072 sc1 lds
    v_mfma_f32_16x16x32_bf16 v[212:215], v[120:123], v[120:123], v[204:207]
    ds_read_b128 a[0:3], v1 offset:59392
    s_add_u32 m0, s93, 131072
    s_add_u32 s94, s92, 131072
    v_mfma_f32_16x16x32_bf16 v[212:215], v[128:131], v[128:131], v[212:215]
    buffer_load_dwordx4 v1, s[8:11], s94 offen offset:0 sc1 lds
    v_mfma_f32_16x16x32_bf16 v[216:219], v[124:127], v[124:127], v[208:211]
    ds_read_b128 a[4:7], v1 offset:63488
    s_waitcnt lgkmcnt(6)
    v_mfma_f32_16x16x32_bf16 v[216:219], v[132:135], v[132:135], v[216:219]
    buffer_load_dwordx4 v1, s[8:11], s94 offen offset:1024 sc1 lds
    v_mfma_f32_16x16x32_bf16 v[188:191], a[8:11], v[104:107], v[188:191]
    v_mfma_f32_16x16x32_bf16 v[188:191], a[12:15], v[112:115], v[188:191]
    s_waitcnt vmcnt(14)
    v_mfma_f32_16x16x32_bf16 v[192:195], a[12:15], v[116:119], v[192:195]
    v_swap_b32 v138, v140
    v_mfma_f32_16x16x32_bf16 v[192:195], a[8:11], v[108:111], v[192:195]
    buffer_load_dwordx4 v1, s[8:11], s94 offen offset:2048 sc1 lds
    v_mfma_f32_16x16x32_bf16 v[200:203], a[16:19], v[108:111], v[200:203]
    ds_read_b128 a[8:11], v1 offset:60416
    v_cmp_u_f32 vcc, v212, v216
    v_mfma_f32_16x16x32_bf16 v[200:203], a[20:23], v[116:119], v[200:203]
    v_swap_b32 v139, v141
    v_mfma_f32_16x16x32_bf16 v[196:199], a[20:23], v[112:115], v[196:199]
    ds_read_b128 a[12:15], v1 offset:64512
    s_waitcnt lgkmcnt(4)
    v_mfma_f32_16x16x32_bf16 v[196:199], a[16:19], v[104:107], v[196:199]
    s_cbranch_vccnz L_hv7
L_hok7:
    v_mfma_f32_16x16x32_bf16 v[172:175], a[24:27], v[120:123], v[172:175]
    ds_read_b128 a[16:19], v4 offset:0
    v_mfma_f32_16x16x32_bf16 v[172:175], a[28:31], v[128:131], v[172:175]
    v_swap_b32 v146, v148
    v_mfma_f32_16x16x32_bf16 v[176:179], a[28:31], v[132:135], v[176:179]
    ds_read_b128 a[20:23], v4 offset:4096
    v_mfma_f32_16x16x32_bf16 v[176:179], a[24:27], v[124:127], v[176:179]
    buffer_load_dwordx4 v1, s[8:11], s94 offen offset:3072 sc1 lds
    v_mfma_f32_16x16x32_bf16 v[184:187], a[32:35], v[124:127], v[184:187]
    ds_read_b128 a[24:27], v4 offset:1024
    s_add_u32 m0, s93, 0
    v_mfma_f32_16x16x32_bf16 v[184:187], a[36:39], v[132:135], v[184:187]
    v_swap_b32 v147, v149
    v_mfma_f32_16x16x32_bf16 v[180:183], a[36:39], v[128:131], v[180:183]
    ds_read_b128 a[28:31], v4 offset:5120
    s_add_u32 s94, s92, 147456
    v_mfma_f32_16x16x32_bf16 v[180:183], a[32:35], v[120:123], v[180:183]
    buffer_load_dwordx4 v1, s[8:11], s94 offen offset:0 sc1 lds
    v_mfma_f32_16x16x32_bf16 v[204:207], v[136:139], v[136:139], v[212:215]
    ds_read_b128 a[32:35], v4 offset:2048
    v_mfma_f32_16x16x32_bf16 v[204:207], v[144:147], v[144:147], v[204:207]
    buffer_load_dwordx4 v1, s[8:11], s94 offen offset:1024 sc1 lds
    v_mfma_f32_16x16x32_bf16 v[208:211], v[140:143], v[140:143], v[216:219]
    ds_read_b128 a[36:39], v4 offset:6144
    s_waitcnt lgkmcnt(6)
    v_mfma_f32_16x16x32_bf16 v[208:211], v[148:151], v[148:151], v[208:211]
    buffer_load_dwordx4 v1, s[8:11], s94 offen offset:2048 sc1 lds
    v_mfma_f32_16x16x32_bf16 v[188:191], a[0:3], v[120:123], v[188:191]
    v_mfma_f32_16x16x32_bf16 v[188:191], a[4:7], v[128:131], v[188:191]
    s_waitcnt vmcnt(15)
    v_mfma_f32_16x16x32_bf16 v[192:195], a[4:7], v[132:135], v[192:195]
    v_swap_b32 v154, v156
    v_mfma_f32_16x16x32_bf16 v[192:195], a[0:3], v[124:127], v[192:195]
    buffer_load_dwordx4 v1, s[8:11], s94 offen offset:3072 sc1 lds
    v_mfma_f32_16x16x32_bf16 v[200:203], a[8:11], v[124:127], v[200:203]
    ds_read_b128 a[0:3], v4 offset:3072
    v_cmp_u_f32 vcc, v204, v208
    v_mfma_f32_16x16x32_bf16 v[200:203], a[12:15], v[132:135], v[200:203]
    v_swap_b32 v155, v157
    v_mfma_f32_16x16x32_bf16 v[196:199], a[12:15], v[128:131], v[196:199]
    ds_read_b128 a[4:7], v4 offset:7168
    s_waitcnt lgkmcnt(4)
    v_mfma_f32_16x16x32_bf16 v[196:199], a[8:11], v[120:123], v[196:199]
    s_cbranch_vccnz L_hv8
L_hok8:
    s_add_u32 m0, s93, 16384
    v_mfma_f32_16x16x32_bf16 v[172:175], a[16:19], v[136:139], v[172:175]
    ds_read_b128 a[8:11], v4 offset:8192
    s_add_u32 s94, s92, 163840
    v_mfma_f32_16x16x32_bf16 v[172:175], a[20:23], v[144:147], v[172:175]
    v_swap_b32 v162, v164
    v_mfma_f32_16x16x32_bf16 v[176:179], a[20:23], v[148:151], v[176:179]
    ds_read_b128 a[12:15], v4 offset:12288
    v_mfma_f32_16x16x32_bf16 v[176:179], a[16:19], v[140:143], v[176:179]
    buffer_load_dwordx4 v1, s[8:11], s94 offen offset:0 sc1 lds
    v_mfma_f32_16x16x32_bf16 v[184:187], a[24:27], v[140:143], v[184:187]
    ds_read_b128 a[16:19], v4 offset:9216
    v_mfma_f32_16x16x32_bf16 v[184:187], a[28:31], v[148:151], v[184:187]
    v_swap_b32 v163, v165
    v_mfma_f32_16x16x32_bf16 v[180:183], a[28:31], v[144:147], v[180:183]
    ds_read_b128 a[20:23], v4 offset:13312
    v_mfma_f32_16x16x32_bf16 v[180:183], a[24:27], v[136:139], v[180:183]
    buffer_load_dwordx4 v1, s[8:11], s94 offen offset:1024 sc1 lds
    v_mfma_f32_16x16x32_bf16 v[212:215], v[152:155], v[152:155], v[204:207]
    ds_read_b128 a[24:27], v4 offset:10240
    v_mfma_f32_16x16x32_bf16 v[212:215], v[160:163], v[160:163], v[212:215]
    buffer_load_dwordx4 v1, s[8:11], s94 offen offset:2048 sc1 lds
    v_mfma_f32_16x16x32_bf16 v[216:219], v[156:159], v[156:159], v[208:211]
    ds_read_b128 a[28:31], v4 offset:14336
    s_waitcnt lgkmcnt(6)
    v_mfma_f32_16x16x32_bf16 v[216:219], v[164:167], v[164:167], v[216:219]
    buffer_load_dwordx4 v1, s[8:11], s94 offen offset:3072 sc1 lds
    v_mfma_f32_16x16x32_bf16 v[188:191], a[32:35], v[136:139], v[188:191]
    v_mfma_f32_16x16x32_bf16 v[188:191], a[36:39], v[144:147], v[188:191]
    s_addk_i32 s95, 4096
    v_mfma_f32_16x16x32_bf16 v[192:195], a[36:39], v[148:151], v[192:195]
    buffer_load_dwordx4 a[136:139], v1, s[8:11], s95 offen offset:0 sc1
    v_mfma_f32_16x16x32_bf16 v[192:195], a[32:35], v[140:143], v[192:195]
    v_mfma_f32_16x16x32_bf16 v[200:203], a[0:3], v[140:143], v[200:203]
    ds_read_b128 a[32:35], v4 offset:11264
    v_cmp_u_f32 vcc, v212, v216
    v_mfma_f32_16x16x32_bf16 v[200:203], a[4:7], v[148:151], v[200:203]
    buffer_load_dwordx4 a[140:143], v1, s[8:11], s95 offen offset:1024 sc1
    v_mfma_f32_16x16x32_bf16 v[196:199], a[4:7], v[144:147], v[196:199]
    ds_read_b128 a[36:39], v4 offset:15360
    v_add_u32 v242, 81920, v3
    s_waitcnt lgkmcnt(4)
    v_mfma_f32_16x16x32_bf16 v[196:199], a[0:3], v[136:139], v[196:199]
    s_waitcnt vmcnt(18)
    s_barrier
    s_cbranch_vccnz L_hv9
L_hok9:
    v_mfma_f32_16x16x32_bf16 v[172:175], a[8:11], v[152:155], v[172:175]
    ds_read_b64_tr_b16 v[220:221], v242 offset:0
    ds_read_b64_tr_b16 v[222:223], v242 offset:32
    v_add_u32 v242, 82944, v3
    s_add_u32 m0, s93, 32768
    s_add_u32 s94, s92, 180224
    v_mfma_f32_16x16x32_bf16 v[172:175], a[12:15], v[160:163], v[172:175]
    buffer_load_dwordx4 v1, s[8:11], s94 offen offset:0 sc1 lds
    v_mfma_f32_16x16x32_bf16 v[176:179], a[12:15], v[164:167], v[176:179]
    ds_read_b64_tr_b16 v[224:225], v242 offset:0
    ds_read_b64_tr_b16 v[226:227], v242 offset:32
    v_cndmask_b32 v238, v238, v212, s[42:43]
    v_mfma_f32_16x16x32_bf16 v[176:179], a[8:11], v[156:159], v[176:179]
    v_cndmask_b32 v239, v239, v216, s[42:43]
    v_cndmask_b32 v238, v238, v213, s[44:45]
    v_mfma_f32_16x16x32_bf16 v[184:187], a[16:19], v[156:159], v[184:187]
    ds_read_b128 a[0:3], v4 offset:18432
    v_cndmask_b32 v239, v239, v217, s[44:45]
    v_cndmask_b32 v238, v238, v214, s[46:47]
    v_mfma_f32_16x16x32_bf16 v[184:187], a[20:23], v[164:167], v[184:187]
    buffer_load_dwordx4 v1, s[8:11], s94 offen offset:1024 sc1 lds
    v_mfma_f32_16x16x32_bf16 v[180:183], a[20:23], v[160:163], v[180:183]
    ds_read_b128 a[4:7], v4 offset:20480
    s_waitcnt lgkmcnt(6)
    v_cndmask_b32 v239, v239, v218, s[46:47]
    v_mfma_f32_16x16x32_bf16 v[180:183], a[16:19], v[152:155], v[180:183]
    v_cndmask_b32 v238, v238, v215, s[36:37]
    v_cndmask_b32 v239, v239, v219, s[36:37]
    v_mfma_f32_16x16x32_bf16 v[188:191], a[24:27], v[152:155], v[188:191]
    ds_read_b128 a[8:11], v4 offset:19456
    v_permlane16_swap_b32 v238, v239
    v_mfma_f32_16x16x32_bf16 v[188:191], a[28:31], v[160:163], v[188:191]
    buffer_load_dwordx4 v1, s[8:11], s94 offen offset:2048 sc1 lds
    v_mfma_f32_16x16x32_bf16 v[192:195], a[28:31], v[164:167], v[192:195]
    ds_read_b128 a[12:15], v4 offset:21504
    v_add_f32 v236, v238, v239
    v_add_f32 v240, v238, v239
    v_mfma_f32_16x16x32_bf16 v[192:195], a[24:27], v[156:159], v[192:195]
    v_mov_b32 v241, v172
    v_mov_b32 v237, v176
    v_mfma_f32_16x16x32_bf16 v[200:203], a[32:35], v[156:159], v[200:203]
    ds_read_b128 a[16:19], v4 offset:22528
    v_permlane32_swap_b32 v236, v240
    v_mfma_f32_16x16x32_bf16 v[200:203], a[36:39], v[164:167], v[200:203]
    v_permlane16_swap_b32 v241, v237
    v_mfma_f32_16x16x32_bf16 v[196:199], a[36:39], v[160:163], v[196:199]
    ds_read_b128 a[20:23], v4 offset:24576
    s_waitcnt lgkmcnt(2)
    v_add_f32 v236, v236, v240
    v_mfma_f32_16x16x32_bf16 v[196:199], a[32:35], v[152:155], v[196:199]
    buffer_load_dwordx4 v1, s[8:11], s94 offen offset:3072 sc1 lds
    v_mfma_f32_16x16x32_bf16 v[204:207], a[0:3], v[8:11], 0
    ds_read_b128 a[24:27], v4 offset:23552
    s_add_u32 m0, s93, 49152
    v_mov_b32 v241, v237
    v_mfma_f32_16x16x32_bf16 v[204:207], a[4:7], v[16:19], v[204:207]
    v_mul_f32 v236, 0x3acccccd, v236
    v_mfma_f32_16x16x32_bf16 v[208:211], a[4:7], v[20:23], 0
    ds_read_b128 a[28:31], v4 offset:25600
    s_add_u32 s94, s92, 196608
    v_mfma_f32_16x16x32_bf16 v[208:211], a[0:3], v[12:15], v[208:211]
    buffer_load_dwordx4 v1, s[8:11], s94 offen offset:0 sc1 lds
    v_mfma_f32_16x16x32_bf16 v[216:219], a[8:11], v[12:15], 0
    ds_read_b128 a[32:35], v4 offset:26624
    v_permlane32_swap_b32 v241, v237
    v_mfma_f32_16x16x32_bf16 v[216:219], a[12:15], v[20:23], v[216:219]
    v_mul_f32 v237, 0xbacccccd, v237
    v_fma_f32 v236, -v237, v237, v236
    v_mfma_f32_16x16x32_bf16 v[212:215], a[12:15], v[16:19], 0
    ds_read_b128 a[36:39], v4 offset:28672
    s_waitcnt lgkmcnt(2)
    v_max_f32 v236, 0, v236
    v_mfma_f32_16x16x32_bf16 v[212:215], a[8:11], v[8:11], v[212:215]
    v_add_f32 v236, 0x3727c5ac, v236
    v_cvt_pk_bf16_f32 v168, v237, v237
    v_mfma_f32_16x16x32_bf16 v[204:207], a[16:19], v[24:27], v[204:207]
    ds_read_b128 a[0:3], v4 offset:27648
    v_rsq_f32 v238, v236
    v_mfma_f32_16x16x32_bf16 v[204:207], a[20:23], v[32:35], v[204:207]
    buffer_load_dwordx4 v1, s[8:11], s94 offen offset:1024 sc1 lds
    v_mfma_f32_16x16x32_bf16 v[208:211], a[20:23], v[36:39], v[208:211]
    ds_read_b128 a[4:7], v4 offset:29696
    v_cvt_pk_bf16_f32 v169, v237, v237
    v_cvt_pk_bf16_f32 v170, v237, v237
    v_mfma_f32_16x16x32_bf16 v[208:211], a[16:19], v[28:31], v[208:211]
    v_cvt_pk_bf16_f32 v171, v237, v237
    v_mul_f32 v239, 0xbfb8aa3b, v238
    v_mfma_f32_16x16x32_bf16 v[216:219], a[24:27], v[28:31], v[216:219]
    ds_read_b128 a[8:11], v4 offset:30720
    v_permlane16_swap_b32 v168, v170
    v_mfma_f32_16x16x32_bf16 v[216:219], a[28:31], v[36:39], v[216:219]
    buffer_load_dwordx4 v1, s[8:11], s94 offen offset:2048 sc1 lds
    v_mfma_f32_16x16x32_bf16 v[212:215], a[28:31], v[32:35], v[212:215]
    ds_read_b128 a[12:15], v4 offset:32768
    s_waitcnt lgkmcnt(2)
    v_mul_f32 v240, 0xbfb8aa3b, v238
    v_mfma_f32_16x16x32_bf16 v[212:215], a[24:27], v[24:27], v[212:215]
    v_permlane16_swap_b32 v169, v171
    v_mfma_f32_16x16x32_bf16 v[204:207], a[32:35], v[40:43], v[204:207]
    ds_read_b128 a[16:19], v4 offset:31744
    v_permlane16_swap_b32 v239, v240
    v_mfma_f32_16x16x32_bf16 v[204:207], a[36:39], v[48:51], v[204:207]
    buffer_load_dwordx4 v1, s[8:11], s94 offen offset:3072 sc1 lds
    v_mfma_f32_16x16x32_bf16 v[208:211], a[36:39], v[52:55], v[208:211]
    ds_read_b128 a[20:23], v4 offset:33792
    v_mul_f32 v237, v236, v238
    v_mul_f32 v236, v236, v238
    v_mfma_f32_16x16x32_bf16 v[208:211], a[32:35], v[44:47], v[208:211]
    v_mfma_f32_16x16x32_bf16 v[216:219], a[0:3], v[44:47], v[216:219]
    ds_read_b128 a[24:27], v4 offset:34816
    v_permlane16_swap_b32 v236, v237
    v_mfma_f32_16x16x32_bf16 v[216:219], a[4:7], v[52:55], v[216:219]
    v_mfma_f32_16x16x32_bf16 v[212:215], a[4:7], v[48:51], v[212:215]
    ds_read_b128 a[28:31], v4 offset:36864
    v_mfma_f32_16x16x32_bf16 v[212:215], a[0:3], v[40:43], v[212:215]
    buffer_load_dwordx4 a[144:147], v1, s[8:11], s95 offen offset:2048 sc1
    v_mfma_f32_16x16x16_bf16 v[172:175], v[220:221], v[168:169], v[172:175]
    ds_read_b128 a[32:35], v4 offset:35840
    v_mfma_f32_16x16x16_bf16 v[176:179], v[220:221], v[170:171], v[176:179]
    v_mfma_f32_16x16x16_bf16 v[184:187], v[222:223], v[170:171], v[184:187]
    ds_read_b128 a[36:39], v4 offset:37888
    v_mfma_f32_16x16x16_bf16 v[180:183], v[222:223], v[168:169], v[180:183]
    buffer_load_dwordx4 a[148:151], v1, s[8:11], s95 offen offset:3072 sc1
    v_mfma_f32_16x16x16_bf16 v[188:191], v[224:225], v[168:169], v[188:191]
    ds_read_b128 a[0:3], v4 offset:38912
    s_addk_i32 s95, 4096
    v_mfma_f32_16x16x16_bf16 v[192:195], v[224:225], v[170:171], v[192:195]
    v_mfma_f32_16x16x16_bf16 v[200:203], v[226:227], v[170:171], v[200:203]
    ds_read_b128 a[4:7], v4 offset:40960
    s_waitcnt lgkmcnt(6)
    v_mul_f32 v172, v239, v172
    v_mfma_f32_16x16x16_bf16 v[196:199], v[226:227], v[168:169], v[196:199]
    v_exp_f32 v172, v172
    v_mfma_f32_16x16x32_bf16 v[204:207], a[8:11], v[56:59], v[204:207]
    buffer_load_dwordx4 a[152:155], v1, s[8:11], s95 offen offset:0 sc1
    v_mul_f32 v173, v239, v173
    v_mfma_f32_16x16x32_bf16 v[204:207], a[12:15], v[64:67], v[204:207]
    v_exp_f32 v173, v173
    v_mfma_f32_16x16x32_bf16 v[208:211], a[12:15], v[68:71], v[208:211]
    v_mul_f32 v174, v239, v174
    v_exp_f32 v174, v174
    v_mfma_f32_16x16x32_bf16 v[208:211], a[8:11], v[60:63], v[208:211]
    v_mul_f32 v175, v239, v175
    v_mul_f32 v176, v240, v176
    v_mfma_f32_16x16x32_bf16 v[216:219], a[16:19], v[60:63], v[216:219]
    ds_read_b128 a[8:11], v4 offset:39936
    v_exp_f32 v175, v175
    v_mfma_f32_16x16x32_bf16 v[216:219], a[20:23], v[68:71], v[216:219]
    buffer_load_dwordx4 a[156:159], v1, s[8:11], s95 offen offset:1024 sc1
    v_mfma_f32_16x16x32_bf16 v[212:215], a[20:23], v[64:67], v[212:215]
    ds_read_b128 a[12:15], v4 offset:41984
    s_waitcnt lgkmcnt(4)
    v_mul_f32 v177, v240, v177
    v_mfma_f32_16x16x32_bf16 v[212:215], a[16:19], v[56:59], v[212:215]
    v_exp_f32 v176, v176
    v_mfma_f32_16x16x32_bf16 v[204:207], a[24:27], v[72:75], v[204:207]
    ds_read_b128 a[16:19], v4 offset:43008
    v_exp_f32 v177, v177
    v_mfma_f32_16x16x32_bf16 v[204:207], a[28:31], v[80:83], v[204:207]
    buffer_load_dwordx4 a[160:163], v1, s[8:11], s95 offen offset:2048 sc1
    v_mfma_f32_16x16x32_bf16 v[208:211], a[28:31], v[84:87], v[208:211]
    ds_read_b128 a[20:23], v4 offset:45056
    v_mul_f32 v178, v240, v178
    v_mul_f32 v179, v240, v179
    v_mfma_f32_16x16x32_bf16 v[208:211], a[24:27], v[76:79], v[208:211]
    v_exp_f32 v178, v178
    v_mfma_f32_16x16x32_bf16 v[216:219], a[32:35], v[76:79], v[216:219]
    ds_read_b128 a[24:27], v4 offset:44032
    v_exp_f32 v179, v179
    v_mfma_f32_16x16x32_bf16 v[216:219], a[36:39], v[84:87], v[216:219]
    v_fma_f32 v172, v172, v236, v236
    v_fma_f32 v173, v173, v236, v236
    v_mfma_f32_16x16x32_bf16 v[212:215], a[36:39], v[80:83], v[212:215]
    ds_read_b128 a[28:31], v4 offset:46080
    s_waitcnt lgkmcnt(4)
    v_fma_f32 v174, v174, v236, v236
    v_mfma_f32_16x16x32_bf16 v[212:215], a[32:35], v[72:75], v[212:215]
    buffer_load_dwordx4 a[164:167], v1, s[8:11], s95 offen offset:3072 sc1
    v_mfma_f32_16x16x32_bf16 v[204:207], a[0:3], v[88:91], v[204:207]
    ds_read_b128 a[32:35], v4 offset:47104
    s_add_u32 m0, s93, 65536
    v_fma_f32 v175, v175, v236, v236
    v_mfma_f32_16x16x32_bf16 v[204:207], a[4:7], v[96:99], v[204:207]
    s_waitcnt vmcnt(24)
    s_barrier
    v_mfma_f32_16x16x32_bf16 v[208:211], a[4:7], v[100:103], v[208:211]
    ds_read_b128 a[36:39], v4 offset:49152
    s_add_u32 s94, s92, 212992
    v_fma_f32 v176, v176, v237, v237
    v_mfma_f32_16x16x32_bf16 v[208:211], a[0:3], v[92:95], v[208:211]
    buffer_load_dwordx4 v1, s[8:11], s94 offen offset:0 sc1 lds
    v_mfma_f32_16x16x32_bf16 v[216:219], a[8:11], v[92:95], v[216:219]
    ds_read_b128 a[0:3], v4 offset:48128
    v_rcp_f32 v172, v172
    v_mfma_f32_16x16x32_bf16 v[216:219], a[12:15], v[100:103], v[216:219]
    v_rcp_f32 v173, v173
    v_mfma_f32_16x16x32_bf16 v[212:215], a[12:15], v[96:99], v[212:215]
    ds_read_b128 a[4:7], v4 offset:50176
    s_waitcnt lgkmcnt(4)
    v_fma_f32 v177, v177, v237, v237
    v_mfma_f32_16x16x32_bf16 v[212:215], a[8:11], v[88:91], v[212:215]
    v_rcp_f32 v174, v174
    v_mfma_f32_16x16x32_bf16 v[204:207], a[16:19], v[104:107], v[204:207]
    ds_read_b128 a[8:11], v4 offset:51200
    v_rcp_f32 v175, v175
    v_mfma_f32_16x16x32_bf16 v[204:207], a[20:23], v[112:115], v[204:207]
    buffer_load_dwordx4 v1, s[8:11], s94 offen offset:1024 sc1 lds
    v_mfma_f32_16x16x32_bf16 v[208:211], a[20:23], v[116:119], v[208:211]
    ds_read_b128 a[12:15], v4 offset:53248
    v_rcp_f32 v176, v176
    v_mfma_f32_16x16x32_bf16 v[208:211], a[16:19], v[108:111], v[208:211]
    v_rcp_f32 v177, v177
    v_mfma_f32_16x16x32_bf16 v[216:219], a[24:27], v[108:111], v[216:219]
    ds_read_b128 a[16:19], v4 offset:52224
    v_fma_f32 v178, v178, v237, v237
    v_fma_f32 v179, v179, v237, v237
    v_mfma_f32_16x16x32_bf16 v[216:219], a[28:31], v[116:119], v[216:219]
    buffer_load_dwordx4 v1, s[8:11], s94 offen offset:2048 sc1 lds
    v_mfma_f32_16x16x32_bf16 v[212:215], a[28:31], v[112:115], v[212:215]
    ds_read_b128 a[20:23], v4 offset:54272
    s_waitcnt lgkmcnt(4)
    v_mul_f32 v180, v180, v172
    v_mfma_f32_16x16x32_bf16 v[212:215], a[24:27], v[104:107], v[212:215]
    v_rcp_f32 v178, v178
    v_mfma_f32_16x16x32_bf16 v[204:207], a[32:35], v[120:123], v[204:207]
    ds_read_b128 a[24:27], v4 offset:55296
    v_rcp_f32 v179, v179
    v_mfma_f32_16x16x32_bf16 v[204:207], a[36:39], v[128:131], v[204:207]
    buffer_load_dwordx4 v1, s[8:11], s94 offen offset:3072 sc1 lds
    v_mfma_f32_16x16x32_bf16 v[208:211], a[36:39], v[132:135], v[208:211]
    ds_read_b128 a[28:31], v4 offset:57344
    v_mul_f32 v181, v181, v173
    v_mul_f32 v182, v182, v174
    v_mfma_f32_16x16x32_bf16 v[208:211], a[32:35], v[124:127], v[208:211]
    v_mul_f32 v183, v183, v175
    v_mul_f32 v184, v184, v176
    v_mfma_f32_16x16x32_bf16 v[216:219], a[0:3], v[124:127], v[216:219]
    ds_read_b128 a[32:35], v4 offset:56320
    s_add_u32 m0, s93, 81920
    v_mul_f32 v185, v185, v177
    v_mfma_f32_16x16x32_bf16 v[216:219], a[4:7], v[132:135], v[216:219]
    v_mul_f32 v186, v186, v178
    v_mul_f32 v187, v187, v179
    v_mfma_f32_16x16x32_bf16 v[212:215], a[4:7], v[128:131], v[212:215]
    ds_read_b128 a[36:39], v4 offset:58368
    v_add_u32 v242, 124928, v3
    s_waitcnt lgkmcnt(4)
    s_add_u32 s94, s92, 229376
    v_mfma_f32_16x16x32_bf16 v[212:215], a[0:3], v[120:123], v[212:215]
    buffer_load_dwordx4 v1, s[8:11], s94 offen offset:0 sc1 lds
    v_mfma_f32_16x16x32_bf16 v[204:207], a[8:11], v[136:139], v[204:207]
    ds_read_b64_tr_b16 a[0:1], v242 offset:0
    ds_read_b64_tr_b16 a[2:3], v242 offset:32
    v_cvt_pk_bf16_f32 v172, v180, v181
    v_mfma_f32_16x16x32_bf16 v[204:207], a[12:15], v[144:147], v[204:207]
    v_cvt_pk_bf16_f32 v174, v184, v185
    v_cvt_pk_bf16_f32 v173, v182, v183
    v_mfma_f32_16x16x32_bf16 v[208:211], a[12:15], v[148:151], v[208:211]
    ds_read_b128 a[4:7], v4 offset:60416
    v_permlane16_swap_b32 v172, v174
    v_mfma_f32_16x16x32_bf16 v[208:211], a[8:11], v[140:143], v[208:211]
    buffer_load_dwordx4 v1, s[8:11], s94 offen offset:1024 sc1 lds
    v_mfma_f32_16x16x32_bf16 v[216:219], a[16:19], v[140:143], v[216:219]
    ds_read_b128 a[8:11], v4 offset:62464
    v_cvt_pk_bf16_f32 v175, v186, v187
    v_mfma_f32_16x16x32_bf16 v[216:219], a[20:23], v[148:151], v[216:219]
    v_mfma_f32_16x16x32_bf16 v[212:215], a[20:23], v[144:147], v[212:215]
    ds_read_b128 a[12:15], v4 offset:61440
    s_waitcnt lgkmcnt(5)
    v_mfma_f32_16x16x32_bf16 v[212:215], a[16:19], v[136:139], v[212:215]
    v_permlane16_swap_b32 v173, v175
    v_mfma_f32_16x16x32_bf16 v[204:207], a[24:27], v[152:155], v[204:207]
    ds_read_b128 a[16:19], v4 offset:63488
    buffer_store_dwordx4 v[172:175], v2, s[8:11], s17 offen offset:0 sc1
    v_mfma_f32_16x16x32_bf16 v[204:207], a[28:31], v[160:163], v[204:207]
    buffer_load_dwordx4 v1, s[8:11], s94 offen offset:2048 sc1 lds
    v_mfma_f32_16x16x32_bf16 v[208:211], a[28:31], v[164:167], v[208:211]
    ds_read_b128 a[20:23], v4 offset:64512
    v_mul_f32 v188, v239, v188
    v_mul_f32 v189, v239, v189
    v_mfma_f32_16x16x32_bf16 v[208:211], a[24:27], v[156:159], v[208:211]
    v_exp_f32 v188, v188
    v_mfma_f32_16x16x32_bf16 v[216:219], a[32:35], v[156:159], v[216:219]
    ds_read_b128 a[24:27], v5 offset:1024
    v_exp_f32 v189, v189
    v_mfma_f32_16x16x32_bf16 v[216:219], a[36:39], v[164:167], v[216:219]
    buffer_load_dwordx4 v1, s[8:11], s94 offen offset:3072 sc1 lds
    v_mfma_f32_16x16x32_bf16 v[212:215], a[36:39], v[160:163], v[212:215]
    ds_read_b128 a[28:31], v5 offset:0
    s_waitcnt lgkmcnt(5)
    v_mul_f32 v190, v239, v190
    v_mfma_f32_16x16x32_bf16 v[212:215], a[32:35], v[152:155], v[212:215]
    v_exp_f32 v190, v190
    v_mfma_f32_16x16x16_bf16 v[204:207], a[0:1], v[168:169], v[204:207]
    ds_read_b128 a[32:35], v5 offset:2048
    v_mul_f32 v191, v239, v191
    v_mul_f32 v192, v240, v192
    v_mfma_f32_16x16x16_bf16 v[208:211], a[0:1], v[170:171], v[208:211]
    v_exp_f32 v191, v191
    v_mfma_f32_16x16x16_bf16 v[216:219], a[2:3], v[170:171], v[216:219]
    ds_read_b128 a[36:39], v5 offset:3072
    v_exp_f32 v192, v192
    v_mfma_f32_16x16x16_bf16 v[212:215], a[2:3], v[168:169], v[212:215]
    buffer_load_dwordx2 v[220:221], v6, s[8:11], s26 offen offset:0 sc1
    v_mfma_f32_16x16x32_bf16 v[172:175], a[4:7], v[8:11], 0
    ds_read_b128 a[0:3], v5 offset:5120
    v_mul_f32 v193, v240, v193
    v_mul_f32 v194, v240, v194
    v_mfma_f32_16x16x32_bf16 v[172:175], a[8:11], v[16:19], v[172:175]
    v_exp_f32 v193, v193
    v_mfma_f32_16x16x32_bf16 v[176:179], a[8:11], v[20:23], 0
    s_waitcnt lgkmcnt(4)
    v_exp_f32 v194, v194
    v_mfma_f32_16x16x32_bf16 v[176:179], a[4:7], v[12:15], v[176:179]
    buffer_load_dwordx2 v[222:223], v6, s[8:11], s26 offen offset:256 sc1
    v_mfma_f32_16x16x32_bf16 v[184:187], a[12:15], v[12:15], 0
    ds_read_b128 a[4:7], v5 offset:4096
    v_mul_f32 v195, v240, v195
    v_fma_f32 v188, v188, v236, v236
    v_mfma_f32_16x16x32_bf16 v[184:187], a[16:19], v[20:23], v[184:187]
    v_exp_f32 v195, v195
    v_mfma_f32_16x16x32_bf16 v[180:183], a[16:19], v[16:19], 0
    ds_read_b128 a[8:11], v5 offset:6144
    v_rcp_f32 v188, v188
    v_mfma_f32_16x16x32_bf16 v[180:183], a[12:15], v[8:11], v[180:183]
    buffer_load_dwordx2 v[224:225], v6, s[8:11], s26 offen offset:2048 sc1
    v_mfma_f32_16x16x32_bf16 v[172:175], a[20:23], v[24:27], v[172:175]
    ds_read_b128 a[12:15], v5 offset:7168
    v_fma_f32 v189, v189, v236, v236
    v_fma_f32 v190, v190, v236, v236
    v_mfma_f32_16x16x32_bf16 v[172:175], a[24:27], v[32:35], v[172:175]
    v_rcp_f32 v189, v189
    v_mfma_f32_16x16x32_bf16 v[176:179], a[24:27], v[36:39], v[176:179]
    ds_read_b128 a[16:19], v5 offset:9216
    s_waitcnt lgkmcnt(4)
    v_fma_f32 v191, v191, v236, v236
    v_mfma_f32_16x16x32_bf16 v[176:179], a[20:23], v[28:31], v[176:179]
    v_rcp_f32 v190, v190
    v_mfma_f32_16x16x32_bf16 v[184:187], a[28:31], v[28:31], v[184:187]
    ds_read_b128 a[20:23], v5 offset:8192
    v_rcp_f32 v191, v191
    v_mfma_f32_16x16x32_bf16 v[184:187], a[32:35], v[36:39], v[184:187]
    buffer_load_dwordx2 v[226:227], v6, s[8:11], s26 offen offset:2304 sc1
    v_mfma_f32_16x16x32_bf16 v[180:183], a[32:35], v[32:35], v[180:183]
    ds_read_b128 a[24:27], v5 offset:10240
    v_fma_f32 v192, v192, v237, v237
    v_fma_f32 v193, v193, v237, v237
    v_mfma_f32_16x16x32_bf16 v[180:183], a[28:31], v[24:27], v[180:183]
    v_rcp_f32 v192, v192
    v_mfma_f32_16x16x32_bf16 v[172:175], a[36:39], v[40:43], v[172:175]
    ds_read_b128 a[28:31], v5 offset:11264
    v_rcp_f32 v193, v193
    v_mfma_f32_16x16x32_bf16 v[172:175], a[0:3], v[48:51], v[172:175]
    buffer_load_dwordx2 v[228:229], v7, s[8:11], s27 offen sc1
    v_mfma_f32_16x16x32_bf16 v[176:179], a[0:3], v[52:55], v[176:179]
    ds_read_b128 a[32:35], v5 offset:13312
    s_waitcnt lgkmcnt(4)
    v_fma_f32 v194, v194, v237, v237
    v_mfma_f32_16x16x32_bf16 v[176:179], a[36:39], v[44:47], v[176:179]
    v_rcp_f32 v194, v194
    v_mfma_f32_16x16x32_bf16 v[184:187], a[4:7], v[44:47], v[184:187]
    ds_read_b128 a[36:39], v5 offset:12288
    s_addk_i32 s95, 4096
    v_fma_f32 v195, v195, v237, v237
    v_mfma_f32_16x16x32_bf16 v[184:187], a[8:11], v[52:55], v[184:187]
    v_rcp_f32 v195, v195
    v_mfma_f32_16x16x32_bf16 v[180:183], a[8:11], v[48:51], v[180:183]
    ds_read_b128 a[0:3], v5 offset:14336
    v_mul_f32 v196, v196, v188
    v_mul_f32 v197, v197, v189
    v_mfma_f32_16x16x32_bf16 v[180:183], a[4:7], v[40:43], v[180:183]
    buffer_load_dwordx4 a[168:171], v1, s[8:11], s95 offen offset:0 sc1
    v_mfma_f32_16x16x32_bf16 v[172:175], a[12:15], v[56:59], v[172:175]
    ds_read_b128 a[4:7], v5 offset:15360
    s_add_u32 m0, s93, 98304
    v_mul_f32 v198, v198, v190
    v_mfma_f32_16x16x32_bf16 v[172:175], a[16:19], v[64:67], v[172:175]
    s_waitcnt vmcnt(25)
    s_barrier
    v_mfma_f32_16x16x32_bf16 v[176:179], a[16:19], v[68:71], v[176:179]
    ds_read_b128 a[8:11], v1 offset:1024
    s_waitcnt lgkmcnt(4)
    s_add_u32 s94, s92, 245760
    v_mfma_f32_16x16x32_bf16 v[176:179], a[12:15], v[60:63], v[176:179]
    buffer_load_dwordx4 v1, s[8:11], s94 offen offset:0 sc1 lds
    v_mfma_f32_16x16x32_bf16 v[184:187], a[20:23], v[60:63], v[184:187]
    ds_read_b128 a[12:15], v1 offset:0
    v_mul_f32 v199, v199, v191
    v_mul_f32 v200, v200, v192
    v_mfma_f32_16x16x32_bf16 v[184:187], a[24:27], v[68:71], v[184:187]
    v_mul_f32 v201, v201, v193
    v_mul_f32 v202, v202, v194
    v_mfma_f32_16x16x32_bf16 v[180:183], a[24:27], v[64:67], v[180:183]
    ds_read_b128 a[16:19], v1 offset:2048
    v_mul_f32 v203, v203, v195
    v_cvt_pk_bf16_f32 v188, v196, v197
    v_mfma_f32_16x16x32_bf16 v[180:183], a[20:23], v[56:59], v[180:183]
    buffer_load_dwordx4 v1, s[8:11], s94 offen offset:1024 sc1 lds
    v_mfma_f32_16x16x32_bf16 v[172:175], a[28:31], v[72:75], v[172:175]
    ds_read_b128 a[20:23], v1 offset:3072
    v_cvt_pk_bf16_f32 v190, v200, v201
    v_cvt_pk_bf16_f32 v189, v198, v199
    v_mfma_f32_16x16x32_bf16 v[172:175], a[32:35], v[80:83], v[172:175]
    v_permlane16_swap_b32 v188, v190
    v_mfma_f32_16x16x32_bf16 v[176:179], a[32:35], v[84:87], v[176:179]
    ds_read_b128 a[24:27], v1 offset:5120
    s_waitcnt lgkmcnt(4)
    v_cvt_pk_bf16_f32 v191, v202, v203
    v_mfma_f32_16x16x32_bf16 v[176:179], a[28:31], v[76:79], v[176:179]
    v_mfma_f32_16x16x32_bf16 v[184:187], a[36:39], v[76:79], v[184:187]
    ds_read_b128 a[28:31], v1 offset:4096
    v_permlane16_swap_b32 v189, v191
    v_mfma_f32_16x16x32_bf16 v[184:187], a[0:3], v[84:87], v[184:187]
    buffer_load_dwordx4 v1, s[8:11], s94 offen offset:2048 sc1 lds
    v_mfma_f32_16x16x32_bf16 v[180:183], a[0:3], v[80:83], v[180:183]
    ds_read_b128 a[32:35], v1 offset:6144
    buffer_store_dwordx4 v[188:191], v2, s[8:11], s17 offen offset:2048 sc1
    v_mfma_f32_16x16x32_bf16 v[180:183], a[36:39], v[72:75], v[180:183]
    s_addk_i32 s17, 4096
    v_mul_f32 v204, v239, v204
    v_mfma_f32_16x16x32_bf16 v[172:175], a[4:7], v[88:91], v[172:175]
    ds_read_b128 a[36:39], v1 offset:7168
    v_exp_f32 v204, v204
    v_mfma_f32_16x16x32_bf16 v[172:175], a[8:11], v[96:99], v[172:175]
    buffer_load_dwordx4 v1, s[8:11], s94 offen offset:3072 sc1 lds
    v_mfma_f32_16x16x32_bf16 v[176:179], a[8:11], v[100:103], v[176:179]
    ds_read_b128 a[0:3], v1 offset:9216
    s_waitcnt lgkmcnt(4)
    v_mul_f32 v205, v239, v205
    v_mfma_f32_16x16x32_bf16 v[176:179], a[4:7], v[92:95], v[176:179]
    v_exp_f32 v205, v205
    v_mfma_f32_16x16x32_bf16 v[184:187], a[12:15], v[92:95], v[184:187]
    ds_read_b128 a[4:7], v1 offset:8192
    s_add_u32 m0, s93, 114688
    v_mul_f32 v206, v239, v206
    v_mfma_f32_16x16x32_bf16 v[184:187], a[16:19], v[100:103], v[184:187]
    v_exp_f32 v206, v206
    v_mfma_f32_16x16x32_bf16 v[180:183], a[16:19], v[96:99], v[180:183]
    ds_read_b128 a[8:11], v1 offset:10240
    s_add_u32 s94, s92, 262144
    v_mul_f32 v207, v239, v207
    v_mfma_f32_16x16x32_bf16 v[180:183], a[12:15], v[88:91], v[180:183]
    buffer_load_dwordx4 v1, s[8:11], s94 offen offset:0 sc1 lds
    v_mfma_f32_16x16x32_bf16 v[172:175], a[20:23], v[104:107], v[172:175]
    ds_read_b128 a[12:15], v1 offset:11264
    v_exp_f32 v207, v207
    v_mfma_f32_16x16x32_bf16 v[172:175], a[24:27], v[112:115], v[172:175]
    v_mul_f32 v208, v240, v208
    v_mul_f32 v209, v240, v209
    v_mfma_f32_16x16x32_bf16 v[176:179], a[24:27], v[116:119], v[176:179]
    ds_read_b128 a[16:19], v1 offset:13312
    s_waitcnt lgkmcnt(4)
    v_mul_f32 v210, v240, v210
    v_mfma_f32_16x16x32_bf16 v[176:179], a[20:23], v[108:111], v[176:179]
    buffer_load_dwordx4 v1, s[8:11], s94 offen offset:1024 sc1 lds
    v_mfma_f32_16x16x32_bf16 v[184:187], a[28:31], v[108:111], v[184:187]
    ds_read_b128 a[20:23], v1 offset:12288
    v_exp_f32 v208, v208
    v_mfma_f32_16x16x32_bf16 v[184:187], a[32:35], v[116:119], v[184:187]
    v_exp_f32 v209, v209
    v_mfma_f32_16x16x32_bf16 v[180:183], a[32:35], v[112:115], v[180:183]
    ds_read_b128 a[24:27], v1 offset:14336
    v_exp_f32 v210, v210
    v_mfma_f32_16x16x32_bf16 v[180:183], a[28:31], v[104:107], v[180:183]
    buffer_load_dwordx4 v1, s[8:11], s94 offen offset:2048 sc1 lds
    v_mfma_f32_16x16x32_bf16 v[172:175], a[36:39], v[120:123], v[172:175]
    ds_read_b128 a[28:31], v1 offset:15360
    v_mul_f32 v211, v240, v211
    v_fma_f32 v204, v204, v236, v236
    v_mfma_f32_16x16x32_bf16 v[172:175], a[0:3], v[128:131], v[172:175]
    v_exp_f32 v211, v211
    v_mfma_f32_16x16x32_bf16 v[176:179], a[0:3], v[132:135], v[176:179]
    ds_read_b128 a[32:35], v1 offset:17408
    s_waitcnt lgkmcnt(4)
    v_fma_f32 v205, v205, v236, v236
    v_mfma_f32_16x16x32_bf16 v[176:179], a[36:39], v[124:127], v[176:179]
    v_rcp_f32 v204, v204
    v_mfma_f32_16x16x32_bf16 v[184:187], a[4:7], v[124:127], v[184:187]
    ds_read_b128 a[36:39], v1 offset:16384
    v_rcp_f32 v205, v205
    v_mfma_f32_16x16x32_bf16 v[184:187], a[8:11], v[132:135], v[184:187]
    buffer_load_dwordx4 v1, s[8:11], s94 offen offset:3072 sc1 lds
    v_mfma_f32_16x16x32_bf16 v[180:183], a[8:11], v[128:131], v[180:183]
    ds_read_b128 a[0:3], v1 offset:18432
    v_add_u32 v242, 19456, v3
    v_fma_f32 v206, v206, v236, v236
    v_mfma_f32_16x16x32_bf16 v[180:183], a[4:7], v[120:123], v[180:183]
    v_rcp_f32 v206, v206
    v_mfma_f32_16x16x32_bf16 v[172:175], a[12:15], v[136:139], v[172:175]
    ds_read_b64_tr_b16 a[4:5], v242 offset:0
    ds_read_b64_tr_b16 a[6:7], v242 offset:32
    v_fma_f32 v207, v207, v236, v236
    v_mfma_f32_16x16x32_bf16 v[172:175], a[16:19], v[144:147], v[172:175]
    buffer_load_dwordx4 a[172:175], v1, s[8:11], s95 offen offset:1024 sc1
    v_mfma_f32_16x16x32_bf16 v[176:179], a[16:19], v[148:151], v[176:179]
    ds_read_b128 a[8:11], v1 offset:20480
    s_waitcnt lgkmcnt(5)
    v_fma_f32 v208, v208, v237, v237
    v_mfma_f32_16x16x32_bf16 v[176:179], a[12:15], v[140:143], v[176:179]
    v_rcp_f32 v207, v207
    v_mfma_f32_16x16x32_bf16 v[184:187], a[20:23], v[140:143], v[184:187]
    ds_read_b128 a[12:15], v1 offset:22528
    v_rcp_f32 v208, v208
    v_mfma_f32_16x16x32_bf16 v[184:187], a[24:27], v[148:151], v[184:187]
    v_fma_f32 v209, v209, v237, v237
    v_fma_f32 v210, v210, v237, v237
    v_mfma_f32_16x16x32_bf16 v[180:183], a[24:27], v[144:147], v[180:183]
    ds_read_b128 a[16:19], v1 offset:21504
    v_rcp_f32 v209, v209
    v_mfma_f32_16x16x32_bf16 v[180:183], a[20:23], v[136:139], v[180:183]
    buffer_load_dwordx4 a[176:179], v1, s[8:11], s95 offen offset:2048 sc1
    v_mfma_f32_16x16x32_bf16 v[172:175], a[28:31], v[152:155], v[172:175]
    ds_read_b128 a[20:23], v1 offset:23552
    v_rcp_f32 v210, v210
    v_mfma_f32_16x16x32_bf16 v[172:175], a[32:35], v[160:163], v[172:175]
    v_fma_f32 v211, v211, v237, v237
    v_mul_f32 v212, v212, v204
    v_mfma_f32_16x16x32_bf16 v[176:179], a[32:35], v[164:167], v[176:179]
    ds_read_b128 a[24:27], v1 offset:24576
    s_waitcnt lgkmcnt(5)
    v_mul_f32 v213, v213, v205
    v_mfma_f32_16x16x32_bf16 v[176:179], a[28:31], v[156:159], v[176:179]
    buffer_load_dwordx4 a[180:183], v1, s[8:11], s95 offen offset:3072 sc1
    v_mfma_f32_16x16x32_bf16 v[184:187], a[36:39], v[156:159], v[184:187]
    ds_read_b128 a[28:31], v1 offset:26624
    v_rcp_f32 v211, v211
    v_mfma_f32_16x16x32_bf16 v[184:187], a[0:3], v[164:167], v[184:187]
    v_mul_f32 v214, v214, v206
    v_mul_f32 v215, v215, v207
    v_mfma_f32_16x16x32_bf16 v[180:183], a[0:3], v[160:163], v[180:183]
    ds_read_b128 a[32:35], v1 offset:25600
    s_addk_i32 s95, 4096
    v_mul_f32 v216, v216, v208
    v_mfma_f32_16x16x32_bf16 v[180:183], a[36:39], v[152:155], v[180:183]
    v_mul_f32 v217, v217, v209
    v_mul_f32 v218, v218, v210
    v_mfma_f32_16x16x16_bf16 v[172:175], a[4:5], v[168:169], v[172:175]
    ds_read_b128 a[36:39], v1 offset:27648
    v_mul_f32 v219, v219, v211
    v_cvt_pk_bf16_f32 v204, v212, v213
    v_mfma_f32_16x16x16_bf16 v[176:179], a[4:5], v[170:171], v[176:179]
    buffer_load_dwordx4 a[184:187], v1, s[8:11], s95 offen offset:0 sc1
    v_mfma_f32_16x16x16_bf16 v[184:187], a[6:7], v[170:171], v[184:187]
    ds_read_b128 a[0:3], v1 offset:28672
    s_waitcnt lgkmcnt(5)
    v_cvt_pk_bf16_f32 v206, v216, v217
    v_mfma_f32_16x16x16_bf16 v[180:183], a[6:7], v[168:169], v[180:183]
    v_cvt_pk_bf16_f32 v205, v214, v215
    v_cvt_pk_bf16_f32 v207, v218, v219
    v_mfma_f32_16x16x32_bf16 v[188:191], a[8:11], v[8:11], 0
    ds_read_b128 a[4:7], v1 offset:30720
    v_permlane16_swap_b32 v204, v206
    v_mfma_f32_16x16x32_bf16 v[188:191], a[12:15], v[16:19], v[188:191]
    buffer_load_dwordx4 a[188:191], v1, s[8:11], s95 offen offset:1024 sc1
    v_mfma_f32_16x16x32_bf16 v[192:195], a[12:15], v[20:23], 0
    v_permlane16_swap_b32 v205, v207
    v_mfma_f32_16x16x32_bf16 v[192:195], a[8:11], v[12:15], v[192:195]
    buffer_store_dwordx4 v[204:207], v2, s[8:11], s17 offen offset:0 sc1
    v_mfma_f32_16x16x32_bf16 v[200:203], a[16:19], v[12:15], 0
    ds_read_b128 a[8:11], v1 offset:29696
    v_mul_f32 v172, v239, v172
    v_mfma_f32_16x16x32_bf16 v[200:203], a[20:23], v[20:23], v[200:203]
    buffer_load_dwordx4 a[192:195], v1, s[8:11], s95 offen offset:2048 sc1
    v_mfma_f32_16x16x32_bf16 v[196:199], a[20:23], v[16:19], 0
    ds_read_b128 a[12:15], v1 offset:31744
    s_waitcnt lgkmcnt(4)
    v_mfma_f32_16x16x32_bf16 v[196:199], a[16:19], v[8:11], v[196:199]
    v_exp_f32 v172, v172
    v_mfma_f32_16x16x32_bf16 v[188:191], a[24:27], v[24:27], v[188:191]
    ds_read_b128 a[16:19], v1 offset:32768
    v_mul_f32 v173, v239, v173
    v_mul_f32 v174, v239, v174
    v_mfma_f32_16x16x32_bf16 v[188:191], a[28:31], v[32:35], v[188:191]
    buffer_load_dwordx4 a[196:199], v1, s[8:11], s95 offen offset:3072 sc1
    v_mfma_f32_16x16x32_bf16 v[192:195], a[28:31], v[36:39], v[192:195]
    ds_read_b128 a[20:23], v1 offset:34816
    s_addk_i32 s95, 4096
    v_mfma_f32_16x16x32_bf16 v[192:195], a[24:27], v[28:31], v[192:195]
    v_exp_f32 v173, v173
    v_mfma_f32_16x16x32_bf16 v[200:203], a[32:35], v[28:31], v[200:203]
    ds_read_b128 a[24:27], v1 offset:33792
    v_mul_f32 v175, v239, v175
    v_mfma_f32_16x16x32_bf16 v[200:203], a[36:39], v[36:39], v[200:203]
    buffer_load_dwordx4 a[200:203], v1, s[8:11], s95 offen offset:0 sc1
    v_mfma_f32_16x16x32_bf16 v[196:199], a[36:39], v[32:35], v[196:199]
    ds_read_b128 a[28:31], v1 offset:35840
    s_waitcnt lgkmcnt(4)
    v_mfma_f32_16x16x32_bf16 v[196:199], a[32:35], v[24:27], v[196:199]
    v_exp_f32 v174, v174
    v_mfma_f32_16x16x32_bf16 v[188:191], a[0:3], v[40:43], v[188:191]
    ds_read_b128 a[32:35], v1 offset:36864
    v_mul_f32 v176, v240, v176
    v_mfma_f32_16x16x32_bf16 v[188:191], a[4:7], v[48:51], v[188:191]
    buffer_load_dwordx4 a[204:207], v1, s[8:11], s95 offen offset:1024 sc1
    v_mfma_f32_16x16x32_bf16 v[192:195], a[4:7], v[52:55], v[192:195]
    ds_read_b128 a[36:39], v1 offset:38912
    v_mul_f32 v177, v240, v177
    v_mfma_f32_16x16x32_bf16 v[192:195], a[0:3], v[44:47], v[192:195]
    v_exp_f32 v175, v175
    v_mfma_f32_16x16x32_bf16 v[200:203], a[8:11], v[44:47], v[200:203]
    ds_read_b128 a[0:3], v1 offset:37888
    v_mul_f32 v178, v240, v178
    v_mfma_f32_16x16x32_bf16 v[200:203], a[12:15], v[52:55], v[200:203]
    buffer_load_dwordx4 a[208:211], v1, s[8:11], s95 offen offset:2048 sc1
    v_mfma_f32_16x16x32_bf16 v[196:199], a[12:15], v[48:51], v[196:199]
    ds_read_b128 a[4:7], v1 offset:39936
    s_waitcnt lgkmcnt(4)
    v_mfma_f32_16x16x32_bf16 v[196:199], a[8:11], v[40:43], v[196:199]
    v_exp_f32 v176, v176
    v_mfma_f32_16x16x32_bf16 v[188:191], a[16:19], v[56:59], v[188:191]
    ds_read_b128 a[8:11], v1 offset:40960
    v_mul_f32 v179, v240, v179
    v_mfma_f32_16x16x32_bf16 v[188:191], a[20:23], v[64:67], v[188:191]
    buffer_load_dwordx4 a[212:215], v1, s[8:11], s95 offen offset:3072 sc1
    v_mfma_f32_16x16x32_bf16 v[192:195], a[20:23], v[68:71], v[192:195]
    ds_read_b128 a[12:15], v1 offset:43008
    s_addk_i32 s95, 4096
    v_mfma_f32_16x16x32_bf16 v[192:195], a[16:19], v[60:63], v[192:195]
    v_exp_f32 v177, v177
    v_mfma_f32_16x16x32_bf16 v[200:203], a[24:27], v[60:63], v[200:203]
    ds_read_b128 a[16:19], v1 offset:41984
    v_fma_f32 v172, v172, v236, v236
    v_mfma_f32_16x16x32_bf16 v[200:203], a[28:31], v[68:71], v[200:203]
    buffer_load_dwordx4 a[216:219], v1, s[8:11], s95 offen offset:0 sc1
    v_mfma_f32_16x16x32_bf16 v[196:199], a[28:31], v[64:67], v[196:199]
    ds_read_b128 a[20:23], v1 offset:44032
    s_waitcnt lgkmcnt(4)
    v_mfma_f32_16x16x32_bf16 v[196:199], a[24:27], v[56:59], v[196:199]
    v_exp_f32 v178, v178
    v_mfma_f32_16x16x32_bf16 v[188:191], a[32:35], v[72:75], v[188:191]
    ds_read_b128 a[24:27], v1 offset:45056
    v_fma_f32 v173, v173, v236, v236
    v_mfma_f32_16x16x32_bf16 v[188:191], a[36:39], v[80:83], v[188:191]
    buffer_load_dwordx4 a[220:223], v1, s[8:11], s95 offen offset:1024 sc1
    v_mfma_f32_16x16x32_bf16 v[192:195], a[36:39], v[84:87], v[192:195]
    ds_read_b128 a[28:31], v1 offset:47104
    v_fma_f32 v174, v174, v236, v236
    v_mfma_f32_16x16x32_bf16 v[192:195], a[32:35], v[76:79], v[192:195]
    v_exp_f32 v179, v179
    v_mfma_f32_16x16x32_bf16 v[200:203], a[0:3], v[76:79], v[200:203]
    ds_read_b128 a[32:35], v1 offset:46080
    v_fma_f32 v175, v175, v236, v236
    v_mfma_f32_16x16x32_bf16 v[200:203], a[4:7], v[84:87], v[200:203]
    buffer_load_dwordx4 a[224:227], v1, s[8:11], s95 offen offset:2048 sc1
    v_mfma_f32_16x16x32_bf16 v[196:199], a[4:7], v[80:83], v[196:199]
    ds_read_b128 a[36:39], v1 offset:48128
    s_waitcnt lgkmcnt(4)
    v_mfma_f32_16x16x32_bf16 v[196:199], a[0:3], v[72:75], v[196:199]
    s_waitcnt vmcnt(9)
    s_barrier
    v_mfma_f32_16x16x32_bf16 v[188:191], a[8:11], v[88:91], v[188:191]
    ds_read_b128 a[0:3], v1 offset:49152
    v_rcp_f32 v172, v172
    v_mfma_f32_16x16x32_bf16 v[188:191], a[12:15], v[96:99], v[188:191]
    buffer_store_dword v253, v252, s[8:11], s18 offen sc1
    v_mfma_f32_16x16x32_bf16 v[192:195], a[12:15], v[100:103], v[192:195]
    ds_read_b128 a[4:7], v1 offset:51200
    s_add_u32 m0, s93, 131072
    v_mfma_f32_16x16x32_bf16 v[192:195], a[8:11], v[92:95], v[192:195]
    v_rcp_f32 v173, v173
    v_mfma_f32_16x16x32_bf16 v[200:203], a[16:19], v[92:95], v[200:203]
    ds_read_b128 a[8:11], v1 offset:50176
    s_add_u32 s94, s92, 278528
    v_mfma_f32_16x16x32_bf16 v[200:203], a[20:23], v[100:103], v[200:203]
    buffer_load_dwordx4 v1, s[8:11], s94 offen offset:0 sc1 lds
    v_mfma_f32_16x16x32_bf16 v[196:199], a[20:23], v[96:99], v[196:199]
    ds_read_b128 a[12:15], v1 offset:52224
    s_waitcnt lgkmcnt(4)
    v_mfma_f32_16x16x32_bf16 v[196:199], a[16:19], v[88:91], v[196:199]
    v_rcp_f32 v174, v174
    v_mfma_f32_16x16x32_bf16 v[188:191], a[24:27], v[104:107], v[188:191]
    ds_read_b128 a[16:19], v1 offset:53248
    v_fma_f32 v176, v176, v237, v237
    v_mfma_f32_16x16x32_bf16 v[188:191], a[28:31], v[112:115], v[188:191]
    buffer_load_dwordx4 v1, s[8:11], s94 offen offset:1024 sc1 lds
    v_mfma_f32_16x16x32_bf16 v[192:195], a[28:31], v[116:119], v[192:195]
    ds_read_b128 a[20:23], v1 offset:55296
    v_fma_f32 v177, v177, v237, v237
    v_mfma_f32_16x16x32_bf16 v[192:195], a[24:27], v[108:111], v[192:195]
    v_rcp_f32 v175, v175
    v_mfma_f32_16x16x32_bf16 v[200:203], a[32:35], v[108:111], v[200:203]
    ds_read_b128 a[24:27], v1 offset:54272
    v_fma_f32 v178, v178, v237, v237
    v_mfma_f32_16x16x32_bf16 v[200:203], a[36:39], v[116:119], v[200:203]
    buffer_load_dwordx4 v1, s[8:11], s94 offen offset:2048 sc1 lds
    v_mfma_f32_16x16x32_bf16 v[196:199], a[36:39], v[112:115], v[196:199]
    ds_read_b128 a[28:31], v1 offset:56320
    s_waitcnt lgkmcnt(4)
    v_mfma_f32_16x16x32_bf16 v[196:199], a[32:35], v[104:107], v[196:199]
    v_rcp_f32 v176, v176
    v_mfma_f32_16x16x32_bf16 v[188:191], a[0:3], v[120:123], v[188:191]
    ds_read_b128 a[32:35], v1 offset:57344
    v_fma_f32 v179, v179, v237, v237
    v_mfma_f32_16x16x32_bf16 v[188:191], a[4:7], v[128:131], v[188:191]
    buffer_load_dwordx4 v1, s[8:11], s94 offen offset:3072 sc1 lds
    v_mfma_f32_16x16x32_bf16 v[192:195], a[4:7], v[132:135], v[192:195]
    ds_read_b128 a[36:39], v1 offset:59392
    v_mul_f32 v180, v180, v172
    v_mfma_f32_16x16x32_bf16 v[192:195], a[0:3], v[124:127], v[192:195]
    v_rcp_f32 v177, v177
    v_mfma_f32_16x16x32_bf16 v[200:203], a[8:11], v[124:127], v[200:203]
    ds_read_b128 a[0:3], v1 offset:58368
    v_mul_f32 v181, v181, v173
    v_mfma_f32_16x16x32_bf16 v[200:203], a[12:15], v[132:135], v[200:203]
    buffer_load_dwordx4 a[228:231], v1, s[8:11], s95 offen offset:3072 sc1
    v_mfma_f32_16x16x32_bf16 v[196:199], a[12:15], v[128:131], v[196:199]
    ds_read_b128 a[4:7], v1 offset:60416
    v_add_u32 v242, 61440, v3
    s_waitcnt lgkmcnt(4)
    v_mfma_f32_16x16x32_bf16 v[196:199], a[8:11], v[120:123], v[196:199]
    v_rcp_f32 v178, v178
    v_mfma_f32_16x16x32_bf16 v[188:191], a[16:19], v[136:139], v[188:191]
    ds_read_b64_tr_b16 a[8:9], v242 offset:0
    ds_read_b64_tr_b16 a[10:11], v242 offset:32
    s_addk_i32 s95, 4096
    v_mfma_f32_16x16x32_bf16 v[188:191], a[20:23], v[144:147], v[188:191]
    buffer_load_dwordx4 a[232:235], v1, s[8:11], s95 offen offset:0 sc1
    v_mfma_f32_16x16x32_bf16 v[192:195], a[20:23], v[148:151], v[192:195]
    ds_read_b128 a[12:15], v1 offset:62464
    v_mul_f32 v182, v182, v174
    v_mfma_f32_16x16x32_bf16 v[192:195], a[16:19], v[140:143], v[192:195]
    v_rcp_f32 v179, v179
    v_mfma_f32_16x16x32_bf16 v[200:203], a[24:27], v[140:143], v[200:203]
    ds_read_b128 a[16:19], v1 offset:64512
    v_mul_f32 v183, v183, v175
    v_mfma_f32_16x16x32_bf16 v[200:203], a[28:31], v[148:151], v[200:203]
    buffer_load_dwordx4 a[236:239], v1, s[8:11], s95 offen offset:1024 sc1
    v_mfma_f32_16x16x32_bf16 v[196:199], a[28:31], v[144:147], v[196:199]
    ds_read_b128 a[20:23], v1 offset:63488
    s_waitcnt lgkmcnt(5)
    v_mfma_f32_16x16x32_bf16 v[196:199], a[24:27], v[136:139], v[196:199]
    v_mul_f32 v184, v184, v176
    v_mul_f32 v185, v185, v177
    v_mfma_f32_16x16x32_bf16 v[188:191], a[32:35], v[152:155], v[188:191]
    ds_read_b128 a[24:27], v4 offset:0
    v_mul_f32 v186, v186, v178
    v_mul_f32 v187, v187, v179
    v_mfma_f32_16x16x32_bf16 v[188:191], a[36:39], v[160:163], v[188:191]
    buffer_load_dwordx4 a[240:243], v1, s[8:11], s95 offen offset:2048 sc1
    v_mfma_f32_16x16x32_bf16 v[192:195], a[36:39], v[164:167], v[192:195]
    ds_read_b128 a[28:31], v4 offset:1024
    v_cvt_pk_bf16_f32 v172, v180, v181
    v_mfma_f32_16x16x32_bf16 v[192:195], a[32:35], v[156:159], v[192:195]
    v_cvt_pk_bf16_f32 v174, v184, v185
    v_cvt_pk_bf16_f32 v173, v182, v183
    v_mfma_f32_16x16x32_bf16 v[200:203], a[0:3], v[156:159], v[200:203]
    ds_read_b128 a[32:35], v4 offset:3072
    v_cvt_pk_bf16_f32 v175, v186, v187
    v_mfma_f32_16x16x32_bf16 v[200:203], a[4:7], v[164:167], v[200:203]
    buffer_load_dwordx4 a[244:247], v1, s[8:11], s95 offen offset:3072 sc1
    v_mfma_f32_16x16x32_bf16 v[196:199], a[4:7], v[160:163], v[196:199]
    ds_read_b128 a[36:39], v4 offset:2048
    s_waitcnt lgkmcnt(5)
    v_mfma_f32_16x16x32_bf16 v[196:199], a[0:3], v[152:155], v[196:199]
    v_permlane16_swap_b32 v172, v174
    v_mfma_f32_16x16x16_bf16 v[188:191], a[8:9], v[168:169], v[188:191]
    ds_read_b128 a[0:3], v4 offset:4096
    s_addk_i32 s95, 4096
    v_mfma_f32_16x16x16_bf16 v[192:195], a[8:9], v[170:171], v[192:195]
    buffer_load_dwordx4 a[248:251], v1, s[8:11], s95 offen offset:0 sc1
    v_mfma_f32_16x16x16_bf16 v[200:203], a[10:11], v[170:171], v[200:203]
    ds_read_b128 a[4:7], v4 offset:5120
    v_mfma_f32_16x16x16_bf16 v[196:199], a[10:11], v[168:169], v[196:199]
    v_permlane16_swap_b32 v173, v175
    v_mfma_f32_16x16x32_bf16 v[204:207], a[12:15], v[8:11], 0
    ds_read_b128 a[8:11], v4 offset:7168
    buffer_store_dwordx4 v[172:175], v2, s[8:11], s17 offen offset:2048 sc1
    v_mfma_f32_16x16x32_bf16 v[204:207], a[16:19], v[16:19], v[204:207]
    buffer_load_dwordx4 a[252:255], v1, s[8:11], s95 offen offset:1024 sc1
    v_mfma_f32_16x16x32_bf16 v[208:211], a[16:19], v[20:23], 0
    s_waitcnt lgkmcnt(4)
    s_addk_i32 s17, 4096
    v_mfma_f32_16x16x32_bf16 v[208:211], a[12:15], v[12:15], v[208:211]
    v_mul_f32 v188, v239, v188
    v_mul_f32 v189, v239, v189
    v_mfma_f32_16x16x32_bf16 v[216:219], a[20:23], v[12:15], 0
    ds_read_b128 a[12:15], v4 offset:6144
    v_mul_f32 v190, v239, v190
    v_mfma_f32_16x16x32_bf16 v[216:219], a[24:27], v[20:23], v[216:219]
    buffer_load_dwordx4 v[244:247], v1, s[8:11], s95 offen offset:2048 sc1
    v_mfma_f32_16x16x32_bf16 v[212:215], a[24:27], v[16:19], 0
    ds_read_b128 a[16:19], v4 offset:8192
    v_mul_f32 v191, v239, v191
    v_mfma_f32_16x16x32_bf16 v[212:215], a[20:23], v[8:11], v[212:215]
    v_exp_f32 v188, v188
    v_mfma_f32_16x16x32_bf16 v[204:207], a[28:31], v[24:27], v[204:207]
    ds_read_b128 a[20:23], v4 offset:9216
    v_mul_f32 v192, v240, v192
    v_mfma_f32_16x16x32_bf16 v[204:207], a[32:35], v[32:35], v[204:207]
    buffer_load_dwordx4 v[248:251], v1, s[8:11], s95 offen offset:3072 sc1
    v_mfma_f32_16x16x32_bf16 v[208:211], a[32:35], v[36:39], v[208:211]
    ds_read_b128 a[24:27], v4 offset:11264
    s_waitcnt lgkmcnt(4)
    v_mfma_f32_16x16x32_bf16 v[208:211], a[28:31], v[28:31], v[208:211]
    v_exp_f32 v189, v189
    v_mfma_f32_16x16x32_bf16 v[216:219], a[36:39], v[28:31], v[216:219]
    ds_read_b128 a[28:31], v4 offset:10240
    v_mul_f32 v193, v240, v193
    v_mfma_f32_16x16x32_bf16 v[216:219], a[0:3], v[36:39], v[216:219]
    v_exp_f32 v190, v190
    v_mfma_f32_16x16x32_bf16 v[212:215], a[0:3], v[32:35], v[212:215]
    ds_read_b128 a[32:35], v4 offset:12288
    v_mul_f32 v194, v240, v194
    v_mfma_f32_16x16x32_bf16 v[212:215], a[36:39], v[24:27], v[212:215]
    v_exp_f32 v191, v191
    v_mfma_f32_16x16x32_bf16 v[204:207], a[4:7], v[40:43], v[204:207]
    ds_read_b128 a[36:39], v4 offset:13312
    v_mul_f32 v195, v240, v195
    v_mfma_f32_16x16x32_bf16 v[204:207], a[8:11], v[48:51], v[204:207]
    v_exp_f32 v192, v192
    v_mfma_f32_16x16x32_bf16 v[208:211], a[8:11], v[52:55], v[208:211]
    ds_read_b128 a[0:3], v4 offset:15360
    s_waitcnt lgkmcnt(4)
    v_mfma_f32_16x16x32_bf16 v[208:211], a[4:7], v[44:47], v[208:211]
    v_exp_f32 v193, v193
    v_mfma_f32_16x16x32_bf16 v[216:219], a[12:15], v[44:47], v[216:219]
    ds_read_b128 a[4:7], v4 offset:14336
    s_add_u32 m0, s30, 0
    v_fma_f32 v188, v188, v236, v236
    v_mfma_f32_16x16x32_bf16 v[216:219], a[16:19], v[52:55], v[216:219]
    s_barrier
    v_mfma_f32_16x16x32_bf16 v[212:215], a[16:19], v[48:51], v[212:215]
    ds_read_b128 a[8:11], v4 offset:16384
    v_fma_f32 v189, v189, v236, v236
    v_mfma_f32_16x16x32_bf16 v[212:215], a[12:15], v[40:43], v[212:215]
    buffer_load_dwordx4 v1, s[8:11], s31 offen offset:0 sc1 lds
    v_mfma_f32_16x16x32_bf16 v[204:207], a[20:23], v[56:59], v[204:207]
    ds_read_b128 a[12:15], v4 offset:17408
    v_fma_f32 v190, v190, v236, v236
    v_mfma_f32_16x16x32_bf16 v[204:207], a[24:27], v[64:67], v[204:207]
    v_exp_f32 v194, v194
    v_mfma_f32_16x16x32_bf16 v[208:211], a[24:27], v[68:71], v[208:211]
    ds_read_b128 a[16:19], v4 offset:19456
    s_waitcnt lgkmcnt(4)
    v_mfma_f32_16x16x32_bf16 v[208:211], a[20:23], v[60:63], v[208:211]
    buffer_load_dwordx4 v1, s[8:11], s31 offen offset:1024 sc1 lds
    v_mfma_f32_16x16x32_bf16 v[216:219], a[28:31], v[60:63], v[216:219]
    ds_read_b128 a[20:23], v4 offset:18432
    v_fma_f32 v191, v191, v236, v236
    v_mfma_f32_16x16x32_bf16 v[216:219], a[32:35], v[68:71], v[216:219]
    v_exp_f32 v195, v195
    v_mfma_f32_16x16x32_bf16 v[212:215], a[32:35], v[64:67], v[212:215]
    ds_read_b128 a[24:27], v4 offset:20480
    v_fma_f32 v192, v192, v237, v237
    v_mfma_f32_16x16x32_bf16 v[212:215], a[28:31], v[56:59], v[212:215]
    buffer_load_dwordx4 v1, s[8:11], s31 offen offset:2048 sc1 lds
    v_mfma_f32_16x16x32_bf16 v[204:207], a[36:39], v[72:75], v[204:207]
    ds_read_b128 a[28:31], v4 offset:21504
    v_fma_f32 v193, v193, v237, v237
    v_mfma_f32_16x16x32_bf16 v[204:207], a[0:3], v[80:83], v[204:207]
    v_rcp_f32 v188, v188
    v_mfma_f32_16x16x32_bf16 v[208:211], a[0:3], v[84:87], v[208:211]
    ds_read_b128 a[32:35], v4 offset:23552
    s_waitcnt lgkmcnt(4)
    v_mfma_f32_16x16x32_bf16 v[208:211], a[36:39], v[76:79], v[208:211]
    buffer_load_dwordx4 v1, s[8:11], s31 offen offset:3072 sc1 lds
    v_mfma_f32_16x16x32_bf16 v[216:219], a[4:7], v[76:79], v[216:219]
    ds_read_b128 a[36:39], v4 offset:22528
    s_addk_i32 s31, 4096
    v_mfma_f32_16x16x32_bf16 v[216:219], a[8:11], v[84:87], v[216:219]
    v_rcp_f32 v189, v189
    v_mfma_f32_16x16x32_bf16 v[212:215], a[8:11], v[80:83], v[212:215]
    ds_read_b128 a[0:3], v4 offset:24576
    s_add_u32 m0, s30, 4096
    v_mfma_f32_16x16x32_bf16 v[212:215], a[4:7], v[72:75], v[212:215]
    buffer_load_dwordx4 v1, s[8:11], s31 offen offset:0 sc1 lds
    v_mfma_f32_16x16x32_bf16 v[204:207], a[12:15], v[88:91], v[204:207]
    ds_read_b128 a[4:7], v4 offset:25600
    v_fma_f32 v194, v194, v237, v237
    v_mfma_f32_16x16x32_bf16 v[204:207], a[16:19], v[96:99], v[204:207]
    v_rcp_f32 v190, v190
    v_mfma_f32_16x16x32_bf16 v[208:211], a[16:19], v[100:103], v[208:211]
    ds_read_b128 a[8:11], v4 offset:27648
    s_waitcnt lgkmcnt(4)
    v_mfma_f32_16x16x32_bf16 v[208:211], a[12:15], v[92:95], v[208:211]
    buffer_load_dword v255, v254, s[8:11], s19 offen sc1
    v_mfma_f32_16x16x32_bf16 v[216:219], a[20:23], v[92:95], v[216:219]
    ds_read_b128 a[12:15], v4 offset:26624
    v_fma_f32 v195, v195, v237, v237
    v_mfma_f32_16x16x32_bf16 v[216:219], a[24:27], v[100:103], v[216:219]
    v_rcp_f32 v191, v191
    v_mfma_f32_16x16x32_bf16 v[212:215], a[24:27], v[96:99], v[212:215]
    ds_read_b128 a[16:19], v4 offset:28672
    v_mul_f32 v196, v196, v188
    v_mfma_f32_16x16x32_bf16 v[212:215], a[20:23], v[88:91], v[212:215]
    buffer_load_dwordx4 v1, s[8:11], s31 offen offset:1024 sc1 lds
    v_mfma_f32_16x16x32_bf16 v[204:207], a[28:31], v[104:107], v[204:207]
    ds_read_b128 a[20:23], v4 offset:29696
    v_mul_f32 v197, v197, v189
    v_mfma_f32_16x16x32_bf16 v[204:207], a[32:35], v[112:115], v[204:207]
    v_rcp_f32 v192, v192
    v_mfma_f32_16x16x32_bf16 v[208:211], a[32:35], v[116:119], v[208:211]
    ds_read_b128 a[24:27], v4 offset:31744
    s_waitcnt lgkmcnt(4)
    v_mfma_f32_16x16x32_bf16 v[208:211], a[28:31], v[108:111], v[208:211]
    buffer_load_dwordx4 v1, s[8:11], s31 offen offset:2048 sc1 lds
    v_mfma_f32_16x16x32_bf16 v[216:219], a[36:39], v[108:111], v[216:219]
    ds_read_b128 a[28:31], v4 offset:30720
    v_rcp_f32 v193, v193
    v_mfma_f32_16x16x32_bf16 v[216:219], a[0:3], v[116:119], v[216:219]
    v_rcp_f32 v194, v194
    v_mfma_f32_16x16x32_bf16 v[212:215], a[0:3], v[112:115], v[212:215]
    ds_read_b128 a[32:35], v4 offset:32768
    v_mul_f32 v198, v198, v190
    v_mfma_f32_16x16x32_bf16 v[212:215], a[36:39], v[104:107], v[212:215]
    buffer_load_dwordx4 v1, s[8:11], s31 offen offset:3072 sc1 lds
    v_mfma_f32_16x16x32_bf16 v[204:207], a[4:7], v[120:123], v[204:207]
    ds_read_b128 a[36:39], v4 offset:33792
    s_addk_i32 s31, 4096
    v_mfma_f32_16x16x32_bf16 v[204:207], a[8:11], v[128:131], v[204:207]
    v_rcp_f32 v195, v195
    v_mfma_f32_16x16x32_bf16 v[208:211], a[8:11], v[132:135], v[208:211]
    ds_read_b128 a[0:3], v4 offset:35840
    s_waitcnt lgkmcnt(4)
    s_add_u32 m0, s30, 8192
    v_mfma_f32_16x16x32_bf16 v[208:211], a[4:7], v[124:127], v[208:211]
    buffer_load_dwordx4 v1, s[8:11], s31 offen offset:0 sc1 lds
    v_mfma_f32_16x16x32_bf16 v[216:219], a[12:15], v[124:127], v[216:219]
    ds_read_b128 a[4:7], v4 offset:34816
    v_mul_f32 v199, v199, v191
    v_mfma_f32_16x16x32_bf16 v[216:219], a[16:19], v[132:135], v[216:219]
    v_mul_f32 v200, v200, v192
    v_mul_f32 v201, v201, v193
    v_mfma_f32_16x16x32_bf16 v[212:215], a[16:19], v[128:131], v[212:215]
    ds_read_b128 a[8:11], v4 offset:36864
    v_add_u32 v242, 103424, v3
    v_mfma_f32_16x16x32_bf16 v[212:215], a[12:15], v[120:123], v[212:215]
    buffer_load_dwordx4 v1, s[8:11], s31 offen offset:1024 sc1 lds
    v_mfma_f32_16x16x32_bf16 v[204:207], a[20:23], v[136:139], v[204:207]
    ds_read_b64_tr_b16 a[12:13], v242 offset:0
    ds_read_b64_tr_b16 a[14:15], v242 offset:32
    v_mfma_f32_16x16x32_bf16 v[204:207], a[24:27], v[144:147], v[204:207]
    v_mul_f32 v202, v202, v194
    v_mul_f32 v203, v203, v195
    v_mfma_f32_16x16x32_bf16 v[208:211], a[24:27], v[148:151], v[208:211]
    ds_read_b128 a[16:19], v4 offset:38912
    s_waitcnt lgkmcnt(5)
    v_mfma_f32_16x16x32_bf16 v[208:211], a[20:23], v[140:143], v[208:211]
    v_cvt_pk_bf16_f32 v188, v196, v197
    v_cvt_pk_bf16_f32 v190, v200, v201
    v_mfma_f32_16x16x32_bf16 v[216:219], a[28:31], v[140:143], v[216:219]
    ds_read_b128 a[20:23], v4 offset:40960
    v_cvt_pk_bf16_f32 v189, v198, v199
    v_mfma_f32_16x16x32_bf16 v[216:219], a[32:35], v[148:151], v[216:219]
    v_permlane16_swap_b32 v188, v190
    v_mfma_f32_16x16x32_bf16 v[212:215], a[32:35], v[144:147], v[212:215]
    ds_read_b128 a[24:27], v4 offset:39936
    v_cvt_pk_bf16_f32 v191, v202, v203
    v_mfma_f32_16x16x32_bf16 v[212:215], a[28:31], v[136:139], v[212:215]
    v_mfma_f32_16x16x32_bf16 v[204:207], a[36:39], v[152:155], v[204:207]
    ds_read_b128 a[28:31], v4 offset:41984
    v_mfma_f32_16x16x32_bf16 v[204:207], a[0:3], v[160:163], v[204:207]
    v_permlane16_swap_b32 v189, v191
    v_mfma_f32_16x16x32_bf16 v[208:211], a[0:3], v[164:167], v[208:211]
    ds_read_b128 a[32:35], v4 offset:43008
    s_waitcnt lgkmcnt(5)
    v_mfma_f32_16x16x32_bf16 v[208:211], a[36:39], v[156:159], v[208:211]
    buffer_store_dwordx4 v[188:191], v2, s[8:11], s17 offen offset:0 sc1
    v_mfma_f32_16x16x32_bf16 v[216:219], a[4:7], v[156:159], v[216:219]
    ds_read_b128 a[36:39], v4 offset:45056
    v_mfma_f32_16x16x32_bf16 v[216:219], a[8:11], v[164:167], v[216:219]
    v_mfma_f32_16x16x32_bf16 v[212:215], a[8:11], v[160:163], v[212:215]
    ds_read_b128 a[0:3], v4 offset:44032
    v_mfma_f32_16x16x32_bf16 v[212:215], a[4:7], v[152:155], v[212:215]
    v_mfma_f32_16x16x16_bf16 v[204:207], a[12:13], v[168:169], v[204:207]
    ds_read_b128 a[4:7], v4 offset:46080
    v_mfma_f32_16x16x16_bf16 v[208:211], a[12:13], v[170:171], v[208:211]
    v_mfma_f32_16x16x16_bf16 v[216:219], a[14:15], v[170:171], v[216:219]
    ds_read_b128 a[8:11], v4 offset:47104
    s_waitcnt lgkmcnt(5)
    v_mfma_f32_16x16x16_bf16 v[212:215], a[14:15], v[168:169], v[212:215]
    s_waitcnt vmcnt(22)
    s_barrier
    v_mfma_f32_16x16x32_bf16 v[172:175], a[16:19], v[8:11], 0
    ds_read_b128 a[12:15], v4 offset:49152
    v_mfma_f32_16x16x32_bf16 v[172:175], a[20:23], v[16:19], v[172:175]
    v_mfma_f32_16x16x32_bf16 v[176:179], a[20:23], v[20:23], 0
    v_mul_f32 v204, v239, v204
    v_mul_f32 v205, v239, v205
    v_mfma_f32_16x16x32_bf16 v[176:179], a[16:19], v[12:15], v[176:179]
    v_exp_f32 v204, v204
    v_mfma_f32_16x16x32_bf16 v[184:187], a[24:27], v[12:15], 0
    ds_read_b128 a[16:19], v4 offset:48128
    v_mul_f32 v206, v239, v206
    v_mfma_f32_16x16x32_bf16 v[184:187], a[28:31], v[20:23], v[184:187]
    s_waitcnt vmcnt(6)
    v_cmp_gt_u32 vcc, 1, v255
    s_nop 0
    s_cbranch_vccnz L_scp1_slow
L_scp1_ok:
    v_mfma_f32_16x16x32_bf16 v[180:183], a[28:31], v[16:19], 0
    ds_read_b128 a[20:23], v4 offset:50176
    s_waitcnt lgkmcnt(4)
    s_add_u32 s19, s19, 32768
    v_mfma_f32_16x16x32_bf16 v[180:183], a[24:27], v[8:11], v[180:183]
    buffer_load_dwordx4 v[8:11], v1, s[8:11], s21 offen offset:0 sc1
    v_mfma_f32_16x16x32_bf16 v[172:175], a[32:35], v[24:27], v[172:175]
    ds_read_b128 a[24:27], v4 offset:51200
    v_mul_f32 v207, v239, v207
    v_mfma_f32_16x16x32_bf16 v[172:175], a[36:39], v[32:35], v[172:175]
    v_exp_f32 v205, v205
    v_mfma_f32_16x16x32_bf16 v[176:179], a[36:39], v[36:39], v[176:179]
    ds_read_b128 a[28:31], v4 offset:53248
    v_mul_f32 v208, v240, v208
    v_mfma_f32_16x16x32_bf16 v[176:179], a[32:35], v[28:31], v[176:179]
    buffer_load_dwordx4 v[12:15], v1, s[8:11], s21 offen offset:1024 sc1
    v_mfma_f32_16x16x32_bf16 v[184:187], a[0:3], v[28:31], v[184:187]
    ds_read_b128 a[32:35], v4 offset:52224
    v_mul_f32 v209, v240, v209
    v_mfma_f32_16x16x32_bf16 v[184:187], a[4:7], v[36:39], v[184:187]
    v_exp_f32 v206, v206
    v_mfma_f32_16x16x32_bf16 v[180:183], a[4:7], v[32:35], v[180:183]
    ds_read_b128 a[36:39], v4 offset:54272
    s_waitcnt lgkmcnt(4)
    v_mfma_f32_16x16x32_bf16 v[180:183], a[0:3], v[24:27], v[180:183]
    buffer_load_dwordx4 v[16:19], v1, s[8:11], s22 offen offset:0 sc1
    v_mfma_f32_16x16x32_bf16 v[172:175], a[8:11], v[40:43], v[172:175]
    ds_read_b128 a[0:3], v4 offset:55296
    v_mul_f32 v210, v240, v210
    v_mfma_f32_16x16x32_bf16 v[172:175], a[12:15], v[48:51], v[172:175]
    v_exp_f32 v207, v207
    v_mfma_f32_16x16x32_bf16 v[176:179], a[12:15], v[52:55], v[176:179]
    ds_read_b128 a[4:7], v4 offset:57344
    v_mul_f32 v211, v240, v211
    v_mfma_f32_16x16x32_bf16 v[176:179], a[8:11], v[44:47], v[176:179]
    buffer_load_dwordx4 v[20:23], v1, s[8:11], s22 offen offset:1024 sc1
    v_mfma_f32_16x16x32_bf16 v[184:187], a[16:19], v[44:47], v[184:187]
    ds_read_b128 a[8:11], v4 offset:56320
    v_fma_f32 v204, v204, v236, v236
    v_mfma_f32_16x16x32_bf16 v[184:187], a[20:23], v[52:55], v[184:187]
    v_exp_f32 v208, v208
    v_mfma_f32_16x16x32_bf16 v[180:183], a[20:23], v[48:51], v[180:183]
    ds_read_b128 a[12:15], v4 offset:58368
    s_waitcnt lgkmcnt(4)
    v_mfma_f32_16x16x32_bf16 v[180:183], a[16:19], v[40:43], v[180:183]
    buffer_load_dwordx4 v[24:27], v1, s[8:11], s23 offen offset:0 sc1
    v_mfma_f32_16x16x32_bf16 v[172:175], a[24:27], v[56:59], v[172:175]
    ds_read_b128 a[16:19], v4 offset:59392
    v_fma_f32 v205, v205, v236, v236
    v_mfma_f32_16x16x32_bf16 v[172:175], a[28:31], v[64:67], v[172:175]
    v_exp_f32 v209, v209
    v_mfma_f32_16x16x32_bf16 v[176:179], a[28:31], v[68:71], v[176:179]
    ds_read_b128 a[20:23], v4 offset:61440
    v_fma_f32 v206, v206, v236, v236
    v_mfma_f32_16x16x32_bf16 v[176:179], a[24:27], v[60:63], v[176:179]
    buffer_load_dwordx4 v[28:31], v1, s[8:11], s23 offen offset:1024 sc1
    v_mfma_f32_16x16x32_bf16 v[184:187], a[32:35], v[60:63], v[184:187]
    ds_read_b128 a[24:27], v4 offset:60416
    v_fma_f32 v207, v207, v236, v236
    v_mfma_f32_16x16x32_bf16 v[184:187], a[36:39], v[68:71], v[184:187]
    v_exp_f32 v210, v210
    v_mfma_f32_16x16x32_bf16 v[180:183], a[36:39], v[64:67], v[180:183]
    ds_read_b128 a[28:31], v4 offset:62464
    s_waitcnt lgkmcnt(4)
    v_mfma_f32_16x16x32_bf16 v[180:183], a[32:35], v[56:59], v[180:183]
    buffer_load_dwordx4 v[32:35], v1, s[8:11], s24 offen offset:0 sc1
    v_mfma_f32_16x16x32_bf16 v[172:175], a[0:3], v[72:75], v[172:175]
    ds_read_b128 a[32:35], v4 offset:63488
    v_exp_f32 v211, v211
    v_mfma_f32_16x16x32_bf16 v[172:175], a[4:7], v[80:83], v[172:175]
    v_rcp_f32 v204, v204
    v_mfma_f32_16x16x32_bf16 v[176:179], a[4:7], v[84:87], v[176:179]
    ds_read_b128 a[36:39], v5 offset:0
    v_fma_f32 v208, v208, v237, v237
    v_mfma_f32_16x16x32_bf16 v[176:179], a[0:3], v[76:79], v[176:179]
    buffer_load_dwordx4 v[36:39], v1, s[8:11], s24 offen offset:1024 sc1
    v_mfma_f32_16x16x32_bf16 v[184:187], a[8:11], v[76:79], v[184:187]
    ds_read_b128 a[0:3], v4 offset:64512
    s_add_u32 s18, s18, 32768
    v_mfma_f32_16x16x32_bf16 v[184:187], a[12:15], v[84:87], v[184:187]
    s_waitcnt vmcnt(8)
    s_barrier
    v_mfma_f32_16x16x32_bf16 v[180:183], a[12:15], v[80:83], v[180:183]
    ds_read_b128 a[4:7], v5 offset:1024
    s_waitcnt lgkmcnt(4)
    v_mfma_f32_16x16x32_bf16 v[180:183], a[8:11], v[72:75], v[180:183]
    buffer_store_dword v253, v252, s[8:11], s18 offen sc1
    v_mfma_f32_16x16x32_bf16 v[172:175], a[16:19], v[88:91], v[172:175]
    ds_read_b128 a[8:11], v5 offset:2048
    v_fma_f32 v209, v209, v237, v237
    v_mfma_f32_16x16x32_bf16 v[172:175], a[20:23], v[96:99], v[172:175]
    v_rcp_f32 v205, v205
    v_mfma_f32_16x16x32_bf16 v[176:179], a[20:23], v[100:103], v[176:179]
    ds_read_b128 a[12:15], v5 offset:4096
    v_fma_f32 v210, v210, v237, v237
    v_mfma_f32_16x16x32_bf16 v[176:179], a[16:19], v[92:95], v[176:179]
    buffer_load_dwordx4 v[40:43], v1, s[8:11], s21 offen offset:2048 sc1
    v_mfma_f32_16x16x32_bf16 v[184:187], a[24:27], v[92:95], v[184:187]
    ds_read_b128 a[16:19], v5 offset:3072
    v_fma_f32 v211, v211, v237, v237
    v_mfma_f32_16x16x32_bf16 v[184:187], a[28:31], v[100:103], v[184:187]
    v_rcp_f32 v206, v206
    v_mfma_f32_16x16x32_bf16 v[180:183], a[28:31], v[96:99], v[180:183]
    ds_read_b128 a[20:23], v5 offset:5120
    s_waitcnt lgkmcnt(4)
    v_mfma_f32_16x16x32_bf16 v[180:183], a[24:27], v[88:91], v[180:183]
    buffer_load_dwordx4 v[44:47], v1, s[8:11], s21 offen offset:3072 sc1
    v_mfma_f32_16x16x32_bf16 v[172:175], a[32:35], v[104:107], v[172:175]
    ds_read_b128 a[24:27], v5 offset:6144
    v_mul_f32 v212, v212, v204
    v_mfma_f32_16x16x32_bf16 v[172:175], a[36:39], v[112:115], v[172:175]
    v_rcp_f32 v207, v207
    v_mfma_f32_16x16x32_bf16 v[176:179], a[36:39], v[116:119], v[176:179]
    ds_read_b128 a[28:31], v5 offset:8192
    v_mul_f32 v213, v213, v205
    v_mfma_f32_16x16x32_bf16 v[176:179], a[32:35], v[108:111], v[176:179]
    buffer_load_dwordx4 v[48:51], v1, s[8:11], s22 offen offset:2048 sc1
    v_mfma_f32_16x16x32_bf16 v[184:187], a[0:3], v[108:111], v[184:187]
    ds_read_b128 a[32:35], v5 offset:7168
    v_mul_f32 v214, v214, v206
    v_mfma_f32_16x16x32_bf16 v[184:187], a[4:7], v[116:119], v[184:187]
    v_rcp_f32 v208, v208
    v_mfma_f32_16x16x32_bf16 v[180:183], a[4:7], v[112:115], v[180:183]
    ds_read_b128 a[36:39], v5 offset:9216
    s_waitcnt lgkmcnt(4)
    v_mfma_f32_16x16x32_bf16 v[180:183], a[0:3], v[104:107], v[180:183]
    buffer_load_dwordx4 v[52:55], v1, s[8:11], s22 offen offset:3072 sc1
    v_mfma_f32_16x16x32_bf16 v[172:175], a[8:11], v[120:123], v[172:175]
    ds_read_b128 a[0:3], v5 offset:10240
    v_mul_f32 v215, v215, v207
    v_mfma_f32_16x16x32_bf16 v[172:175], a[12:15], v[128:131], v[172:175]
    v_rcp_f32 v209, v209
    v_mfma_f32_16x16x32_bf16 v[176:179], a[12:15], v[132:135], v[176:179]
    ds_read_b128 a[4:7], v5 offset:12288
    v_mul_f32 v216, v216, v208
    v_mfma_f32_16x16x32_bf16 v[176:179], a[8:11], v[124:127], v[176:179]
    buffer_load_dwordx4 v[56:59], v1, s[8:11], s23 offen offset:2048 sc1
    v_mfma_f32_16x16x32_bf16 v[184:187], a[16:19], v[124:127], v[184:187]
    ds_read_b128 a[8:11], v5 offset:11264
    v_mul_f32 v217, v217, v209
    v_mfma_f32_16x16x32_bf16 v[184:187], a[20:23], v[132:135], v[184:187]
    v_rcp_f32 v210, v210
    v_mfma_f32_16x16x32_bf16 v[180:183], a[20:23], v[128:131], v[180:183]
    ds_read_b128 a[12:15], v5 offset:13312
    v_add_u32 v242, 145408, v3
    s_waitcnt lgkmcnt(4)
    v_mfma_f32_16x16x32_bf16 v[180:183], a[16:19], v[120:123], v[180:183]
    buffer_load_dwordx4 v[60:63], v1, s[8:11], s23 offen offset:3072 sc1
    v_mfma_f32_16x16x32_bf16 v[172:175], a[24:27], v[136:139], v[172:175]
    ds_read_b64_tr_b16 a[16:17], v242 offset:0
    ds_read_b64_tr_b16 a[18:19], v242 offset:32
    v_mul_f32 v218, v218, v210
    v_mfma_f32_16x16x32_bf16 v[172:175], a[28:31], v[144:147], v[172:175]
    v_rcp_f32 v211, v211
    v_mfma_f32_16x16x32_bf16 v[176:179], a[28:31], v[148:151], v[176:179]
    buffer_load_dwordx4 v[64:67], v1, s[8:11], s24 offen offset:2048 sc1
    v_mfma_f32_16x16x32_bf16 v[176:179], a[24:27], v[140:143], v[176:179]
    v_mul_f32 v219, v219, v211
    v_cvt_pk_bf16_f32 v204, v212, v213
    v_mfma_f32_16x16x32_bf16 v[184:187], a[32:35], v[140:143], v[184:187]
    v_cvt_pk_bf16_f32 v206, v216, v217
    v_cvt_pk_bf16_f32 v205, v214, v215
    v_mfma_f32_16x16x32_bf16 v[184:187], a[36:39], v[148:151], v[184:187]
    v_permlane16_swap_b32 v204, v206
    v_mfma_f32_16x16x32_bf16 v[180:183], a[36:39], v[144:147], v[180:183]
    s_waitcnt lgkmcnt(2)
    v_cvt_pk_bf16_f32 v207, v218, v219
    v_mfma_f32_16x16x32_bf16 v[180:183], a[32:35], v[136:139], v[180:183]
    buffer_load_dwordx4 v[68:71], v1, s[8:11], s24 offen offset:3072 sc1
    v_mfma_f32_16x16x32_bf16 v[172:175], a[0:3], v[152:155], v[172:175]
    v_permlane16_swap_b32 v205, v207
    v_mfma_f32_16x16x32_bf16 v[172:175], a[4:7], v[160:163], v[172:175]
    s_addk_i32 s21, 4096
    buffer_store_dwordx4 v[204:207], v2, s[8:11], s17 offen offset:2048 sc1
    v_mfma_f32_16x16x32_bf16 v[176:179], a[4:7], v[164:167], v[176:179]
    buffer_load_dwordx4 v[72:75], v1, s[8:11], s21 offen offset:0 sc1
    v_mfma_f32_16x16x32_bf16 v[176:179], a[0:3], v[156:159], v[176:179]
    s_addk_i32 s17, 4096
    v_lshlrev_b32 v188, 16, v220
    v_mfma_f32_16x16x32_bf16 v[184:187], a[8:11], v[156:159], v[184:187]
    v_and_b32 v189, s59, v220
    v_lshlrev_b32 v190, 16, v221
    v_mfma_f32_16x16x32_bf16 v[184:187], a[12:15], v[164:167], v[184:187]
    v_and_b32 v191, s59, v221
    v_lshlrev_b32 v192, 16, v222
    v_mfma_f32_16x16x32_bf16 v[180:183], a[12:15], v[160:163], v[180:183]
    s_waitcnt lgkmcnt(0)
    v_and_b32 v193, s59, v222
    v_mfma_f32_16x16x32_bf16 v[180:183], a[8:11], v[152:155], v[180:183]
    buffer_load_dwordx4 v[76:79], v1, s[8:11], s21 offen offset:1024 sc1
    v_mfma_f32_16x16x16_bf16 v[172:175], a[16:17], v[168:169], v[172:175]
    v_lshlrev_b32 v194, 16, v223
    v_and_b32 v195, s59, v223
    v_mfma_f32_16x16x16_bf16 v[176:179], a[16:17], v[170:171], v[176:179]
    s_addk_i32 s22, 4096
    v_lshlrev_b32 v196, 16, v224
    v_mfma_f32_16x16x16_bf16 v[184:187], a[18:19], v[170:171], v[184:187]
    buffer_load_dwordx4 v[80:83], v1, s[8:11], s22 offen offset:0 sc1
    v_mfma_f32_16x16x16_bf16 v[180:183], a[18:19], v[168:169], v[180:183]
    s_waitcnt vmcnt(19)
    v_and_b32 v197, s59, v224
    v_mfma_f32_16x16x32_bf16 v[140:143], a[40:43], v[8:11], 0
    v_lshlrev_b32 v198, 16, v225
    v_and_b32 v199, s59, v225
    v_lshlrev_b32 v200, 16, v226
    v_and_b32 v201, s59, v226
    v_mfma_f32_16x16x32_bf16 v[140:143], a[60:63], v[12:15], v[140:143]
    v_lshlrev_b32 v202, 16, v227
    v_and_b32 v203, s59, v227
    v_lshlrev_b32 v232, 16, v228
    v_and_b32 v233, s59, v228
    v_mfma_f32_16x16x32_bf16 v[144:147], a[64:67], v[12:15], 0
    buffer_load_dwordx4 v[84:87], v1, s[8:11], s22 offen offset:1024 sc1
    v_lshlrev_b32 v234, 16, v229
    v_and_b32 v235, s59, v229
    v_mfma_f32_16x16x32_bf16 v[144:147], a[44:47], v[8:11], v[144:147]
    v_mul_f32 v172, v239, v172
    v_exp_f32 v172, v172
    v_mul_f32 v173, v239, v173
    v_mfma_f32_16x16x32_bf16 v[148:151], a[48:51], v[8:11], 0
    v_exp_f32 v173, v173
    v_mul_f32 v174, v239, v174
    v_mul_f32 v175, v239, v175
    v_mfma_f32_16x16x32_bf16 v[148:151], a[68:71], v[12:15], v[148:151]
    s_addk_i32 s23, 4096
    v_exp_f32 v174, v174
    v_mul_f32 v176, v240, v176
    v_mfma_f32_16x16x32_bf16 v[152:155], a[72:75], v[12:15], 0
    buffer_load_dwordx4 v[88:91], v1, s[8:11], s23 offen offset:0 sc1
    v_exp_f32 v175, v175
    v_mfma_f32_16x16x32_bf16 v[152:155], a[52:55], v[8:11], v[152:155]
    v_exp_f32 v176, v176
    v_mul_f32 v177, v240, v177
    v_mul_f32 v178, v240, v178
    v_mfma_f32_16x16x32_bf16 v[156:159], a[56:59], v[8:11], 0
    v_exp_f32 v177, v177
    v_exp_f32 v178, v178
    v_mfma_f32_16x16x32_bf16 v[156:159], a[76:79], v[12:15], v[156:159]
    s_waitcnt vmcnt(19)
    v_mul_f32 v179, v240, v179
    v_exp_f32 v179, v179
    v_mfma_f32_16x16x32_bf16 v[160:163], a[40:43], v[16:19], 0
    buffer_load_dwordx4 v[92:95], v1, s[8:11], s23 offen offset:1024 sc1
    v_fma_f32 v172, v172, v236, v236
    v_fma_f32 v173, v173, v236, v236
    v_mfma_f32_16x16x32_bf16 v[160:163], a[60:63], v[20:23], v[160:163]
    v_rcp_f32 v172, v172
    v_rcp_f32 v173, v173
    v_mfma_f32_16x16x32_bf16 v[164:167], a[64:67], v[20:23], 0
    v_fma_f32 v174, v174, v236, v236
    v_rcp_f32 v174, v174
    v_fma_f32 v175, v175, v236, v236
    v_mfma_f32_16x16x32_bf16 v[164:167], a[44:47], v[16:19], v[164:167]
    v_rcp_f32 v175, v175
    v_fma_f32 v176, v176, v237, v237
    v_fma_f32 v177, v177, v237, v237
    v_mfma_f32_16x16x32_bf16 v[168:171], a[48:51], v[16:19], 0
    s_addk_i32 s24, 4096
    v_rcp_f32 v176, v176
    v_fma_f32 v178, v178, v237, v237
    v_mfma_f32_16x16x32_bf16 v[168:171], a[68:71], v[20:23], v[168:171]
    buffer_load_dwordx4 v[96:99], v1, s[8:11], s24 offen offset:0 sc1
    v_rcp_f32 v177, v177
    v_mfma_f32_16x16x32_bf16 v[204:207], a[72:75], v[20:23], 0
    v_rcp_f32 v178, v178
    v_fma_f32 v179, v179, v237, v237
    v_mul_f32 v180, v180, v172
    v_mfma_f32_16x16x32_bf16 v[204:207], a[52:55], v[16:19], v[204:207]
    v_rcp_f32 v179, v179
    v_mul_f32 v181, v181, v173
    v_mul_f32 v182, v182, v174
    v_mfma_f32_16x16x32_bf16 v[208:211], a[56:59], v[16:19], 0
    v_mul_f32 v183, v183, v175
    v_mul_f32 v184, v184, v176
    v_mul_f32 v185, v185, v177
    v_mul_f32 v186, v186, v178
    v_mfma_f32_16x16x32_bf16 v[208:211], a[76:79], v[20:23], v[208:211]
    s_waitcnt vmcnt(19)
    v_mul_f32 v187, v187, v179
    v_cvt_pk_bf16_f32 v172, v180, v181
    v_cvt_pk_bf16_f32 v174, v184, v185
    v_mfma_f32_16x16x32_bf16 v[212:215], a[40:43], v[24:27], 0
    buffer_load_dword v255, v254, s[8:11], s19 offen sc1
    v_permlane16_swap_b32 v172, v174
    v_mfma_f32_16x16x32_bf16 v[212:215], a[60:63], v[28:31], v[212:215]
    v_cvt_pk_bf16_f32 v173, v182, v183
    v_cvt_pk_bf16_f32 v175, v186, v187
    v_mfma_f32_16x16x32_bf16 v[216:219], a[64:67], v[28:31], 0
    v_mfma_f32_16x16x32_bf16 v[216:219], a[44:47], v[24:27], v[216:219]
    buffer_load_dwordx4 v[100:103], v1, s[8:11], s24 offen offset:1024 sc1
    v_permlane16_swap_b32 v173, v175
    v_mfma_f32_16x16x32_bf16 v[220:223], a[48:51], v[24:27], 0
    buffer_store_dwordx4 v[172:175], v2, s[8:11], s17 offen offset:0 sc1
    s_add_u32 s39, s33, 1
    s_and_b32 s39, s39, 3
    v_mfma_f32_16x16x32_bf16 v[220:223], a[68:71], v[28:31], v[220:223]
    s_mul_i32 s39, s39, 15360
    s_add_u32 s39, s39, 65536
    v_add_u32 v2, s39, v1
    s_add_u32 s39, s33, 2
    v_mfma_f32_16x16x32_bf16 v[224:227], a[72:75], v[28:31], 0
    s_and_b32 s39, s39, 3
    s_mul_i32 s39, s39, 15360
    s_add_u32 s39, s39, 65536
    v_add_u32 v3, s39, v1
    v_mfma_f32_16x16x32_bf16 v[224:227], a[52:55], v[24:27], v[224:227]
    s_addk_i32 s95, 4096
    s_add_u32 s39, s33, 3
    s_and_b32 s39, s39, 3
    s_mul_i32 s39, s39, 15360
    v_mfma_f32_16x16x32_bf16 v[228:231], a[56:59], v[24:27], 0
    buffer_load_dwordx4 a[0:3], v1, s[8:11], s95 offen offset:0 sc1
    s_add_u32 s39, s39, 65536
    v_add_u32 v4, s39, v1
    v_mfma_f32_16x16x32_bf16 v[228:231], a[76:79], v[28:31], v[228:231]
    s_waitcnt vmcnt(21)
    s_add_u32 s39, s33, 4
    s_and_b32 s39, s39, 3
    s_mul_i32 s39, s39, 15360
    v_mfma_f32_16x16x32_bf16 v[188:191], a[40:43], v[32:35], v[188:191]
    s_add_u32 s39, s39, 65536
    v_add_u32 v5, s39, v1
    v_lshrrev_b32 v236, 4, v0
    v_and_b32 v6, 15, v0
    v_mfma_f32_16x16x32_bf16 v[188:191], a[60:63], v[36:39], v[188:191]
    v_mul_u32_u24 v6, 176, v6
    s_add_u32 s39, s93, 131072
    v_add_u32 v6, s39, v6
    v_mul_u32_u24 v237, 205, v0
    v_mfma_f32_16x16x32_bf16 v[192:195], a[64:67], v[36:39], v[192:195]
    buffer_load_dwordx4 a[4:7], v1, s[8:11], s95 offen offset:1024 sc1
    v_lshrrev_b32 v237, 11, v237
    v_lshl_add_u32 v238, v237, 4, v1
    v_mfma_f32_16x16x32_bf16 v[192:195], a[44:47], v[32:35], v[192:195]
    v_add_u32 v238, s39, v238
    v_mul_u32_u24 v237, 1120, v237
    v_add_u32 v237, v237, v1
    s_add_u32 s34, s28, 7680
    v_mfma_f32_16x16x32_bf16 v[196:199], a[48:51], v[32:35], v[196:199]
    s_waitcnt vmcnt(12)
    s_barrier
    s_add_u32 s35, s28, 15360
    v_lshl_add_u32 v7, v236, 3, v6
    v_mfma_f32_16x16x32_bf16 v[196:199], a[68:71], v[36:39], v[196:199]
    s_add_u32 s18, s18, 32768
    v_lshl_add_u32 v6, v236, 4, v6
    v_mfma_f32_16x16x32_bf16 v[200:203], a[72:75], v[36:39], v[200:203]
    buffer_store_dword v253, v252, s[8:11], s18 offen sc1
    v_mfma_f32_16x16x32_bf16 v[200:203], a[52:55], v[32:35], v[200:203]
    v_mfma_f32_16x16x32_bf16 v[232:235], a[56:59], v[32:35], v[232:235]
    v_mfma_f32_16x16x32_bf16 v[232:235], a[76:79], v[36:39], v[232:235]
    v_mfma_f32_16x16x32_bf16 v[140:143], a[80:83], v[40:43], v[140:143]
    v_mfma_f32_16x16x32_bf16 v[140:143], a[100:103], v[44:47], v[140:143]
    buffer_load_dwordx4 a[8:11], v1, s[8:11], s95 offen offset:2048 sc1
    v_mfma_f32_16x16x32_bf16 v[144:147], a[104:107], v[44:47], v[144:147]
    v_mfma_f32_16x16x32_bf16 v[144:147], a[84:87], v[40:43], v[144:147]
    v_mfma_f32_16x16x32_bf16 v[148:151], a[88:91], v[40:43], v[148:151]
    v_mfma_f32_16x16x32_bf16 v[148:151], a[108:111], v[44:47], v[148:151]
    buffer_load_dwordx4 a[12:15], v1, s[8:11], s95 offen offset:3072 sc1
    v_mfma_f32_16x16x32_bf16 v[152:155], a[112:115], v[44:47], v[152:155]
    v_mfma_f32_16x16x32_bf16 v[152:155], a[92:95], v[40:43], v[152:155]
    v_mfma_f32_16x16x32_bf16 v[156:159], a[96:99], v[40:43], v[156:159]
    v_mfma_f32_16x16x32_bf16 v[156:159], a[116:119], v[44:47], v[156:159]
    v_mfma_f32_16x16x32_bf16 v[160:163], a[80:83], v[48:51], v[160:163]
    v_mfma_f32_16x16x32_bf16 v[160:163], a[100:103], v[52:55], v[160:163]
    v_mfma_f32_16x16x32_bf16 v[164:167], a[104:107], v[52:55], v[164:167]
    v_mfma_f32_16x16x32_bf16 v[164:167], a[84:87], v[48:51], v[164:167]
    v_mfma_f32_16x16x32_bf16 v[168:171], a[88:91], v[48:51], v[168:171]
    v_mfma_f32_16x16x32_bf16 v[168:171], a[108:111], v[52:55], v[168:171]
    v_mfma_f32_16x16x32_bf16 v[204:207], a[112:115], v[52:55], v[204:207]
    v_mfma_f32_16x16x32_bf16 v[204:207], a[92:95], v[48:51], v[204:207]
    v_mfma_f32_16x16x32_bf16 v[208:211], a[96:99], v[48:51], v[208:211]
    v_mfma_f32_16x16x32_bf16 v[208:211], a[116:119], v[52:55], v[208:211]
    v_mfma_f32_16x16x32_bf16 v[212:215], a[80:83], v[56:59], v[212:215]
    v_mfma_f32_16x16x32_bf16 v[212:215], a[100:103], v[60:63], v[212:215]
    v_mfma_f32_16x16x32_bf16 v[216:219], a[104:107], v[60:63], v[216:219]
    v_mfma_f32_16x16x32_bf16 v[216:219], a[84:87], v[56:59], v[216:219]
    v_mfma_f32_16x16x32_bf16 v[220:223], a[88:91], v[56:59], v[220:223]
    v_mfma_f32_16x16x32_bf16 v[220:223], a[108:111], v[60:63], v[220:223]
    s_waitcnt vmcnt(7)
    v_cmp_gt_u32 vcc, 1, v255
    s_nop 0
    s_cbranch_vccnz L_scp2_slow
L_scp2_ok:
    v_mfma_f32_16x16x32_bf16 v[224:227], a[112:115], v[60:63], v[224:227]
    s_add_u32 s19, s19, 32768
    v_mfma_f32_16x16x32_bf16 v[224:227], a[92:95], v[56:59], v[224:227]
    buffer_load_dwordx4 v[104:107], v1, s[8:11], s21 offen offset:2048 sc1
    v_mfma_f32_16x16x32_bf16 v[228:231], a[96:99], v[56:59], v[228:231]
    v_mfma_f32_16x16x32_bf16 v[228:231], a[116:119], v[60:63], v[228:231]
    v_mfma_f32_16x16x32_bf16 v[188:191], a[80:83], v[64:67], v[188:191]
    buffer_load_dwordx4 v[108:111], v1, s[8:11], s21 offen offset:3072 sc1
    v_mfma_f32_16x16x32_bf16 v[188:191], a[100:103], v[68:71], v[188:191]
    v_mfma_f32_16x16x32_bf16 v[192:195], a[104:107], v[68:71], v[192:195]
    v_mfma_f32_16x16x32_bf16 v[192:195], a[84:87], v[64:67], v[192:195]
    v_mfma_f32_16x16x32_bf16 v[196:199], a[88:91], v[64:67], v[196:199]
    buffer_load_dwordx4 v[112:115], v1, s[8:11], s22 offen offset:2048 sc1
    v_mfma_f32_16x16x32_bf16 v[196:199], a[108:111], v[68:71], v[196:199]
    v_mfma_f32_16x16x32_bf16 v[200:203], a[112:115], v[68:71], v[200:203]
    v_mfma_f32_16x16x32_bf16 v[200:203], a[92:95], v[64:67], v[200:203]
    v_mfma_f32_16x16x32_bf16 v[232:235], a[96:99], v[64:67], v[232:235]
    v_mfma_f32_16x16x32_bf16 v[232:235], a[116:119], v[68:71], v[232:235]
    v_mfma_f32_16x16x32_bf16 v[140:143], a[120:123], v[72:75], v[140:143]
    buffer_load_dwordx4 v[116:119], v1, s[8:11], s22 offen offset:3072 sc1
    v_mfma_f32_16x16x32_bf16 v[140:143], a[140:143], v[76:79], v[140:143]
    v_mfma_f32_16x16x32_bf16 v[144:147], a[144:147], v[76:79], v[144:147]
    v_mfma_f32_16x16x32_bf16 v[144:147], a[124:127], v[72:75], v[144:147]
    buffer_load_dwordx4 v[120:123], v1, s[8:11], s23 offen offset:2048 sc1
    v_mfma_f32_16x16x32_bf16 v[148:151], a[128:131], v[72:75], v[148:151]
    v_mfma_f32_16x16x32_bf16 v[148:151], a[148:151], v[76:79], v[148:151]
    v_mfma_f32_16x16x32_bf16 v[152:155], a[152:155], v[76:79], v[152:155]
    s_waitcnt vmcnt(10)
    s_barrier
    s_add_u32 s18, s18, 32768
    v_mfma_f32_16x16x32_bf16 v[152:155], a[132:135], v[72:75], v[152:155]
    buffer_store_dword v253, v252, s[8:11], s18 offen sc1
    v_mfma_f32_16x16x32_bf16 v[156:159], a[136:139], v[72:75], v[156:159]
    v_mfma_f32_16x16x32_bf16 v[156:159], a[156:159], v[76:79], v[156:159]
    ds_read_b128 a[40:43], v1 offset:0
    v_mfma_f32_16x16x32_bf16 v[160:163], a[120:123], v[80:83], v[160:163]
    v_mfma_f32_16x16x32_bf16 v[160:163], a[140:143], v[84:87], v[160:163]
    ds_read_b128 a[44:47], v1 offset:1024
    v_mfma_f32_16x16x32_bf16 v[164:167], a[144:147], v[84:87], v[164:167]
    buffer_load_dword v255, v254, s[8:11], s19 offen sc1
    v_mfma_f32_16x16x32_bf16 v[164:167], a[124:127], v[80:83], v[164:167]
    ds_read_b128 a[48:51], v1 offset:2048
    v_mfma_f32_16x16x32_bf16 v[168:171], a[128:131], v[80:83], v[168:171]
    v_mfma_f32_16x16x32_bf16 v[168:171], a[148:151], v[84:87], v[168:171]
    ds_read_b128 a[52:55], v1 offset:3072
    v_mfma_f32_16x16x32_bf16 v[204:207], a[152:155], v[84:87], v[204:207]
    buffer_load_dwordx4 v[124:127], v1, s[8:11], s23 offen offset:3072 sc1
    v_mfma_f32_16x16x32_bf16 v[204:207], a[132:135], v[80:83], v[204:207]
    ds_read_b128 a[56:59], v1 offset:4096
    v_mfma_f32_16x16x32_bf16 v[208:211], a[136:139], v[80:83], v[208:211]
    v_mfma_f32_16x16x32_bf16 v[208:211], a[156:159], v[84:87], v[208:211]
    s_addk_i32 s21, 4096
    v_mfma_f32_16x16x32_bf16 v[212:215], a[120:123], v[88:91], v[212:215]
    buffer_load_dwordx4 v[128:131], v1, s[8:11], s21 offen offset:0 sc1
    v_mfma_f32_16x16x32_bf16 v[212:215], a[140:143], v[92:95], v[212:215]
    ds_read_b128 a[60:63], v1 offset:5120
    v_mfma_f32_16x16x32_bf16 v[216:219], a[144:147], v[92:95], v[216:219]
    v_mfma_f32_16x16x32_bf16 v[216:219], a[124:127], v[88:91], v[216:219]
    ds_read_b128 a[64:67], v1 offset:6144
    v_mfma_f32_16x16x32_bf16 v[220:223], a[128:131], v[88:91], v[220:223]
    v_mfma_f32_16x16x32_bf16 v[220:223], a[148:151], v[92:95], v[220:223]
    buffer_load_dwordx4 v[132:135], v1, s[8:11], s21 offen offset:1024 sc1
    v_mfma_f32_16x16x32_bf16 v[224:227], a[152:155], v[92:95], v[224:227]
    ds_read_b128 a[68:71], v1 offset:7168
    v_mfma_f32_16x16x32_bf16 v[224:227], a[132:135], v[88:91], v[224:227]
    v_mfma_f32_16x16x32_bf16 v[228:231], a[136:139], v[88:91], v[228:231]
    ds_read_b128 a[72:75], v1 offset:8192
    v_mfma_f32_16x16x32_bf16 v[228:231], a[156:159], v[92:95], v[228:231]
    s_addk_i32 s22, 4096
    v_mfma_f32_16x16x32_bf16 v[188:191], a[120:123], v[96:99], v[188:191]
    buffer_load_dwordx4 v[136:139], v1, s[8:11], s22 offen offset:0 sc1
    v_mfma_f32_16x16x32_bf16 v[188:191], a[140:143], v[100:103], v[188:191]
    ds_read_b128 a[76:79], v1 offset:9216
    v_mfma_f32_16x16x32_bf16 v[192:195], a[144:147], v[100:103], v[192:195]
    v_mfma_f32_16x16x32_bf16 v[192:195], a[124:127], v[96:99], v[192:195]
    buffer_load_dwordx4 v[8:11], v1, s[8:11], s22 offen offset:1024 sc1
    v_mfma_f32_16x16x32_bf16 v[196:199], a[128:131], v[96:99], v[196:199]
    ds_read_b128 a[80:83], v1 offset:10240
    v_mfma_f32_16x16x32_bf16 v[196:199], a[148:151], v[100:103], v[196:199]
    v_mfma_f32_16x16x32_bf16 v[200:203], a[152:155], v[100:103], v[200:203]
    ds_read_b128 a[84:87], v1 offset:11264
    v_mfma_f32_16x16x32_bf16 v[200:203], a[132:135], v[96:99], v[200:203]
    s_addk_i32 s23, 4096
    v_mfma_f32_16x16x32_bf16 v[232:235], a[136:139], v[96:99], v[232:235]
    buffer_load_dwordx4 v[12:15], v1, s[8:11], s23 offen offset:0 sc1
    v_mfma_f32_16x16x32_bf16 v[232:235], a[156:159], v[100:103], v[232:235]
    s_waitcnt vmcnt(11)
    ds_read_b128 a[88:91], v1 offset:12288
    v_mfma_f32_16x16x32_bf16 v[140:143], a[160:163], v[104:107], v[140:143]
    v_mfma_f32_16x16x32_bf16 v[140:143], a[180:183], v[108:111], v[140:143]
    ds_read_b128 a[92:95], v1 offset:13312
    v_mfma_f32_16x16x32_bf16 v[144:147], a[184:187], v[108:111], v[144:147]
    buffer_load_dwordx4 v[16:19], v1, s[8:11], s23 offen offset:1024 sc1
    v_mfma_f32_16x16x32_bf16 v[144:147], a[164:167], v[104:107], v[144:147]
    ds_read_b128 a[96:99], v1 offset:14336
    v_mfma_f32_16x16x32_bf16 v[148:151], a[168:171], v[104:107], v[148:151]
    v_mfma_f32_16x16x32_bf16 v[148:151], a[188:191], v[108:111], v[148:151]
    ds_read_b128 a[100:103], v1 offset:15360
    v_mfma_f32_16x16x32_bf16 v[152:155], a[192:195], v[108:111], v[152:155]
    v_mfma_f32_16x16x32_bf16 v[152:155], a[172:175], v[104:107], v[152:155]
    ds_read_b128 a[104:107], v1 offset:16384
    v_mfma_f32_16x16x32_bf16 v[156:159], a[176:179], v[104:107], v[156:159]
    v_mfma_f32_16x16x32_bf16 v[156:159], a[196:199], v[108:111], v[156:159]
    s_waitcnt vmcnt(10)
    ds_read_b128 a[108:111], v1 offset:17408
    v_mfma_f32_16x16x32_bf16 v[160:163], a[160:163], v[112:115], v[160:163]
    v_mfma_f32_16x16x32_bf16 v[160:163], a[180:183], v[116:119], v[160:163]
    ds_read_b128 a[112:115], v1 offset:18432
    v_mfma_f32_16x16x32_bf16 v[164:167], a[184:187], v[116:119], v[164:167]
    v_mfma_f32_16x16x32_bf16 v[164:167], a[164:167], v[112:115], v[164:167]
    ds_read_b128 a[116:119], v1 offset:19456
    v_mfma_f32_16x16x32_bf16 v[168:171], a[168:171], v[112:115], v[168:171]
    v_mfma_f32_16x16x32_bf16 v[168:171], a[188:191], v[116:119], v[168:171]
    ds_read_b128 a[120:123], v1 offset:20480
    v_mfma_f32_16x16x32_bf16 v[204:207], a[192:195], v[116:119], v[204:207]
    s_waitcnt vmcnt(7)
    v_cmp_gt_u32 vcc, 1, v255
    s_nop 0
    s_cbranch_vccnz L_scp3_slow
L_scp3_ok:
    v_mfma_f32_16x16x32_bf16 v[204:207], a[172:175], v[112:115], v[204:207]
    buffer_load_dwordx4 v[20:23], v1, s[8:11], s21 offen offset:2048 sc1
    v_mfma_f32_16x16x32_bf16 v[208:211], a[176:179], v[112:115], v[208:211]
    v_and_b32 v254, 15, v0
    ds_read_b128 a[124:127], v1 offset:21504
    v_mfma_f32_16x16x32_bf16 v[208:211], a[196:199], v[116:119], v[208:211]
    s_waitcnt vmcnt(7)
    v_mul_u32_u24 v254, 128, v254
    v_mfma_f32_16x16x32_bf16 v[212:215], a[160:163], v[120:123], v[212:215]
    buffer_load_dwordx4 v[24:27], v1, s[8:11], s21 offen offset:3072 sc1
    v_mfma_f32_16x16x32_bf16 v[212:215], a[180:183], v[124:127], v[212:215]
    ds_read_b128 a[128:131], v1 offset:22528
    v_mfma_f32_16x16x32_bf16 v[216:219], a[184:187], v[124:127], v[216:219]
    v_mfma_f32_16x16x32_bf16 v[216:219], a[164:167], v[120:123], v[216:219]
    ds_read_b128 a[132:135], v1 offset:23552
    v_mfma_f32_16x16x32_bf16 v[220:223], a[168:171], v[120:123], v[220:223]
    buffer_load_dwordx4 v[28:31], v1, s[8:11], s22 offen offset:2048 sc1
    v_mfma_f32_16x16x32_bf16 v[220:223], a[188:191], v[124:127], v[220:223]
    ds_read_b128 a[136:139], v1 offset:24576
    v_mfma_f32_16x16x32_bf16 v[224:227], a[192:195], v[124:127], v[224:227]
    v_mfma_f32_16x16x32_bf16 v[224:227], a[172:175], v[120:123], v[224:227]
    ds_read_b128 a[140:143], v1 offset:25600
    v_mfma_f32_16x16x32_bf16 v[228:231], a[176:179], v[120:123], v[228:231]
    v_mfma_f32_16x16x32_bf16 v[228:231], a[196:199], v[124:127], v[228:231]
    s_waitcnt vmcnt(7)
    ds_read_b128 a[144:147], v1 offset:26624
    v_mfma_f32_16x16x32_bf16 v[140:143], a[200:203], v[128:131], v[140:143]
    buffer_load_dwordx4 v[32:35], v1, s[8:11], s22 offen offset:3072 sc1
    v_mfma_f32_16x16x32_bf16 v[140:143], a[220:223], v[132:135], v[140:143]
    ds_read_b128 a[148:151], v1 offset:27648
    v_mfma_f32_16x16x32_bf16 v[144:147], a[224:227], v[132:135], v[144:147]
    v_mfma_f32_16x16x32_bf16 v[144:147], a[204:207], v[128:131], v[144:147]
    buffer_load_dwordx4 v[36:39], v1, s[8:11], s23 offen offset:2048 sc1
    v_mfma_f32_16x16x32_bf16 v[148:151], a[208:211], v[128:131], v[148:151]
    ds_read_b128 a[152:155], v1 offset:28672
    v_mfma_f32_16x16x32_bf16 v[148:151], a[228:231], v[132:135], v[148:151]
    v_mfma_f32_16x16x32_bf16 v[152:155], a[232:235], v[132:135], v[152:155]
    ds_read_b128 a[156:159], v1 offset:29696
    v_mfma_f32_16x16x32_bf16 v[152:155], a[212:215], v[128:131], v[152:155]
    buffer_load_dword v255, v254, s[8:11], s20 offen sc1
    v_mfma_f32_16x16x32_bf16 v[156:159], a[216:219], v[128:131], v[156:159]
    v_mfma_f32_16x16x32_bf16 v[156:159], a[236:239], v[132:135], v[156:159]
    s_waitcnt vmcnt(8)
    v_mfma_f32_16x16x32_bf16 v[160:163], a[200:203], v[136:139], v[160:163]
    v_mfma_f32_16x16x32_bf16 v[160:163], a[220:223], v[8:11], v[160:163]
    v_mfma_f32_16x16x32_bf16 v[164:167], a[224:227], v[8:11], v[164:167]
    buffer_load_dwordx4 v[40:43], v1, s[8:11], s23 offen offset:3072 sc1
    v_mfma_f32_16x16x32_bf16 v[164:167], a[204:207], v[136:139], v[164:167]
    v_mfma_f32_16x16x32_bf16 v[168:171], a[208:211], v[136:139], v[168:171]
    v_mfma_f32_16x16x32_bf16 v[168:171], a[228:231], v[8:11], v[168:171]
    v_mfma_f32_16x16x32_bf16 v[204:207], a[232:235], v[8:11], v[204:207]
    buffer_load_dwordx4 v[44:47], v1, s[8:11], s24 offen offset:2048 sc1
    v_mfma_f32_16x16x32_bf16 v[204:207], a[212:215], v[136:139], v[204:207]
    v_mfma_f32_16x16x32_bf16 v[208:211], a[216:219], v[136:139], v[208:211]
    v_mfma_f32_16x16x32_bf16 v[208:211], a[236:239], v[8:11], v[208:211]
    s_waitcnt vmcnt(8)
    v_mfma_f32_16x16x32_bf16 v[212:215], a[200:203], v[12:15], v[212:215]
    buffer_load_dwordx4 v[48:51], v1, s[8:11], s24 offen offset:3072 sc1
    v_mfma_f32_16x16x32_bf16 v[212:215], a[220:223], v[16:19], v[212:215]
    v_mfma_f32_16x16x32_bf16 v[216:219], a[224:227], v[16:19], v[216:219]
    v_mfma_f32_16x16x32_bf16 v[216:219], a[204:207], v[12:15], v[216:219]
    v_mfma_f32_16x16x32_bf16 v[220:223], a[208:211], v[12:15], v[220:223]
    s_addk_i32 s24, 4096
    v_mfma_f32_16x16x32_bf16 v[220:223], a[228:231], v[16:19], v[220:223]
    buffer_load_dwordx4 v[52:55], v1, s[8:11], s24 offen offset:0 sc1
    v_mfma_f32_16x16x32_bf16 v[224:227], a[232:235], v[16:19], v[224:227]
    v_mfma_f32_16x16x32_bf16 v[224:227], a[212:215], v[12:15], v[224:227]
    v_mfma_f32_16x16x32_bf16 v[228:231], a[216:219], v[12:15], v[228:231]
    v_mfma_f32_16x16x32_bf16 v[228:231], a[236:239], v[16:19], v[228:231]
    s_waitcnt vmcnt(8)
    v_mfma_f32_16x16x32_bf16 v[140:143], a[240:243], v[20:23], v[140:143]
    buffer_load_dwordx4 v[56:59], v1, s[8:11], s24 offen offset:1024 sc1
    v_mfma_f32_16x16x32_bf16 v[140:143], v[248:251], v[24:27], v[140:143]
    v_mfma_f32_16x16x32_bf16 v[144:147], a[0:3], v[24:27], v[144:147]
    v_mfma_f32_16x16x32_bf16 v[144:147], a[244:247], v[20:23], v[144:147]
    buffer_load_dwordx4 v[60:63], v1, s[8:11], s24 offen offset:2048 sc1
    v_mfma_f32_16x16x32_bf16 v[148:151], a[248:251], v[20:23], v[148:151]
    v_mfma_f32_16x16x32_bf16 v[148:151], a[4:7], v[24:27], v[148:151]
    v_mfma_f32_16x16x32_bf16 v[152:155], a[8:11], v[24:27], v[152:155]
    v_mfma_f32_16x16x32_bf16 v[152:155], a[252:255], v[20:23], v[152:155]
    v_mfma_f32_16x16x32_bf16 v[156:159], v[244:247], v[20:23], v[156:159]
    buffer_load_dwordx4 v[64:67], v1, s[8:11], s24 offen offset:3072 sc1
    v_mfma_f32_16x16x32_bf16 v[156:159], a[12:15], v[24:27], v[156:159]
    s_waitcnt vmcnt(9)
    v_mfma_f32_16x16x32_bf16 v[160:163], a[240:243], v[28:31], v[160:163]
    v_mfma_f32_16x16x32_bf16 v[160:163], v[248:251], v[32:35], v[160:163]
    v_mfma_f32_16x16x32_bf16 v[164:167], a[0:3], v[32:35], v[164:167]
    v_mfma_f32_16x16x32_bf16 v[164:167], a[244:247], v[28:31], v[164:167]
    ds_write_b128 v2, v[140:143] offset:0
    v_mfma_f32_16x16x32_bf16 v[168:171], a[248:251], v[28:31], v[168:171]
    v_mfma_f32_16x16x32_bf16 v[168:171], a[4:7], v[32:35], v[168:171]
    v_mfma_f32_16x16x32_bf16 v[204:207], a[8:11], v[32:35], v[204:207]
    ds_write_b128 v2, v[144:147] offset:1024
    v_mfma_f32_16x16x32_bf16 v[204:207], a[252:255], v[28:31], v[204:207]
    v_mfma_f32_16x16x32_bf16 v[208:211], v[244:247], v[28:31], v[208:211]
    v_mfma_f32_16x16x32_bf16 v[208:211], a[12:15], v[32:35], v[208:211]
    s_waitcnt vmcnt(6)
    v_mfma_f32_16x16x32_bf16 v[212:215], a[240:243], v[36:39], v[212:215]
    ds_write_b128 v2, v[148:151] offset:2048
    v_mfma_f32_16x16x32_bf16 v[212:215], v[248:251], v[40:43], v[212:215]
    v_mfma_f32_16x16x32_bf16 v[216:219], a[0:3], v[40:43], v[216:219]
    v_cmp_gt_u32 vcc, 1, v255
    s_nop 0
    s_cbranch_vccnz L_scp4_slow
L_scp4_ok:
    v_mfma_f32_16x16x32_bf16 v[216:219], a[244:247], v[36:39], v[216:219]
    ds_write_b128 v2, v[152:155] offset:3072
    v_mfma_f32_16x16x32_bf16 v[220:223], a[248:251], v[36:39], v[220:223]
    buffer_load_dwordx4 v[68:71], v1, s[8:11], s25 offen offset:0 sc1
    v_mfma_f32_16x16x32_bf16 v[220:223], a[4:7], v[40:43], v[220:223]
    v_mfma_f32_16x16x32_bf16 v[224:227], a[8:11], v[40:43], v[224:227]
    ds_write_b128 v2, v[156:159] offset:4096
    v_mfma_f32_16x16x32_bf16 v[224:227], a[252:255], v[36:39], v[224:227]
    buffer_load_dwordx4 v[72:75], v1, s[8:11], s25 offen offset:1024 sc1
    v_mfma_f32_16x16x32_bf16 v[228:231], v[244:247], v[36:39], v[228:231]
    v_mfma_f32_16x16x32_bf16 v[228:231], a[12:15], v[40:43], v[228:231]
    s_waitcnt vmcnt(6)
    s_addk_i32 s25, 14336
    v_mfma_f32_16x16x32_bf16 v[188:191], a[160:163], v[44:47], v[188:191]
    ds_write_b128 v3, v[160:163] offset:5120
    v_mfma_f32_16x16x32_bf16 v[188:191], a[180:183], v[48:51], v[188:191]
    buffer_load_dwordx4 v[76:79], v1, s[8:11], s25 offen offset:0 sc1
    v_mfma_f32_16x16x32_bf16 v[192:195], a[184:187], v[48:51], v[192:195]
    ds_read_b128 a[160:163], v1 offset:30720
    v_mfma_f32_16x16x32_bf16 v[192:195], a[164:167], v[44:47], v[192:195]
    ds_write_b128 v3, v[164:167] offset:6144
    v_mfma_f32_16x16x32_bf16 v[196:199], a[168:171], v[44:47], v[196:199]
    ds_read_b128 a[164:167], v1 offset:31744
    v_mfma_f32_16x16x32_bf16 v[196:199], a[188:191], v[48:51], v[196:199]
    v_mfma_f32_16x16x32_bf16 v[200:203], a[192:195], v[48:51], v[200:203]
    ds_write_b128 v3, v[168:171] offset:7168
    v_mfma_f32_16x16x32_bf16 v[200:203], a[172:175], v[44:47], v[200:203]
    buffer_load_dwordx4 v[80:83], v1, s[8:11], s25 offen offset:1024 sc1
    v_mfma_f32_16x16x32_bf16 v[232:235], a[176:179], v[44:47], v[232:235]
    ds_read_b128 a[168:171], v1 offset:32768
    v_mfma_f32_16x16x32_bf16 v[232:235], a[196:199], v[48:51], v[232:235]
    s_waitcnt vmcnt(6)
    s_addk_i32 s25, 14336
    v_mfma_f32_16x16x32_bf16 v[188:191], a[200:203], v[52:55], v[188:191]
    ds_write_b128 v3, v[204:207] offset:8192
    v_mfma_f32_16x16x32_bf16 v[188:191], a[220:223], v[56:59], v[188:191]
    buffer_load_dwordx4 v[84:87], v1, s[8:11], s25 offen offset:0 sc1
    v_mfma_f32_16x16x32_bf16 v[192:195], a[224:227], v[56:59], v[192:195]
    ds_read_b128 a[172:175], v1 offset:33792
    v_mfma_f32_16x16x32_bf16 v[192:195], a[204:207], v[52:55], v[192:195]
    ds_write_b128 v3, v[208:211] offset:9216
    v_mfma_f32_16x16x32_bf16 v[196:199], a[208:211], v[52:55], v[196:199]
    buffer_load_dwordx4 v[88:91], v1, s[8:11], s25 offen offset:1024 sc1
    v_mfma_f32_16x16x32_bf16 v[196:199], a[228:231], v[56:59], v[196:199]
    ds_read_b128 a[176:179], v1 offset:34816
    v_mfma_f32_16x16x32_bf16 v[200:203], a[232:235], v[56:59], v[200:203]
    ds_write_b128 v4, v[212:215] offset:10240
    v_mfma_f32_16x16x32_bf16 v[200:203], a[212:215], v[52:55], v[200:203]
    ds_read_b128 a[180:183], v1 offset:35840
    v_mfma_f32_16x16x32_bf16 v[232:235], a[216:219], v[52:55], v[232:235]
    v_mfma_f32_16x16x32_bf16 v[232:235], a[236:239], v[56:59], v[232:235]
    s_waitcnt vmcnt(6)
    s_addk_i32 s25, 14336
    v_mfma_f32_16x16x32_bf16 v[188:191], a[240:243], v[60:63], v[188:191]
    ds_write_b128 v4, v[216:219] offset:11264
    v_mfma_f32_16x16x32_bf16 v[188:191], v[248:251], v[64:67], v[188:191]
    buffer_load_dwordx4 v[92:95], v1, s[8:11], s25 offen offset:0 sc1
    v_mfma_f32_16x16x32_bf16 v[192:195], a[0:3], v[64:67], v[192:195]
    ds_read_b128 a[184:187], v1 offset:36864
    v_mfma_f32_16x16x32_bf16 v[192:195], a[244:247], v[60:63], v[192:195]
    ds_write_b128 v4, v[220:223] offset:12288
    v_mfma_f32_16x16x32_bf16 v[196:199], a[248:251], v[60:63], v[196:199]
    buffer_load_dwordx4 v[96:99], v1, s[8:11], s25 offen offset:1024 sc1
    v_mfma_f32_16x16x32_bf16 v[196:199], a[4:7], v[64:67], v[196:199]
    ds_read_b128 a[188:191], v1 offset:37888
    v_mfma_f32_16x16x32_bf16 v[200:203], a[8:11], v[64:67], v[200:203]
    ds_write_b128 v4, v[224:227] offset:13312
    v_mfma_f32_16x16x32_bf16 v[200:203], a[252:255], v[60:63], v[200:203]
    ds_read_b128 a[192:195], v1 offset:38912
    v_mfma_f32_16x16x32_bf16 v[232:235], v[244:247], v[60:63], v[232:235]
    v_mfma_f32_16x16x32_bf16 v[232:235], a[12:15], v[64:67], v[232:235]
    s_waitcnt vmcnt(6)
    ds_read_b128 a[196:199], v1 offset:39936
    s_waitcnt lgkmcnt(15)
    v_mfma_f32_16x16x32_bf16 v[188:191], a[40:43], v[68:71], v[188:191]
    ds_write_b128 v4, v[228:231] offset:14336
    v_mfma_f32_16x16x32_bf16 v[188:191], a[60:63], v[72:75], v[188:191]
    v_mfma_f32_16x16x32_bf16 v[192:195], a[64:67], v[72:75], v[192:195]
    v_mfma_f32_16x16x32_bf16 v[192:195], a[44:47], v[68:71], v[192:195]
    s_waitcnt lgkmcnt(0)
    s_barrier
    v_mfma_f32_16x16x32_bf16 v[196:199], a[48:51], v[68:71], v[196:199]
    ds_read_b128 v[140:143], v5 offset:0
    ds_read_b128 v[160:163], v5 offset:5120
    v_mfma_f32_16x16x32_bf16 v[196:199], a[68:71], v[72:75], v[196:199]
    ds_read_b128 v[212:215], v5 offset:10240
    ds_read_b128 v[144:147], v5 offset:1024
    v_mfma_f32_16x16x32_bf16 v[200:203], a[72:75], v[72:75], v[200:203]
    ds_read_b128 v[164:167], v5 offset:6144
    ds_read_b128 v[216:219], v5 offset:11264
    v_mfma_f32_16x16x32_bf16 v[200:203], a[52:55], v[68:71], v[200:203]
    ds_read_b128 v[148:151], v5 offset:2048
    ds_read_b128 v[168:171], v5 offset:7168
    v_mfma_f32_16x16x32_bf16 v[232:235], a[56:59], v[68:71], v[232:235]
    ds_read_b128 v[220:223], v5 offset:12288
    ds_read_b128 v[152:155], v5 offset:3072
    v_mfma_f32_16x16x32_bf16 v[232:235], a[76:79], v[72:75], v[232:235]
    s_waitcnt vmcnt(4)
    ds_read_b128 v[204:207], v5 offset:8192
    v_mfma_f32_16x16x32_bf16 v[188:191], a[80:83], v[76:79], v[188:191]
    ds_read_b128 v[224:227], v5 offset:13312
    ds_read_b128 v[156:159], v5 offset:4096
    v_mfma_f32_16x16x32_bf16 v[188:191], a[100:103], v[80:83], v[188:191]
    ds_read_b128 v[208:211], v5 offset:9216
    ds_read_b128 v[228:231], v5 offset:14336
    v_mfma_f32_16x16x32_bf16 v[192:195], a[104:107], v[80:83], v[192:195]
    v_mfma_f32_16x16x32_bf16 v[192:195], a[84:87], v[76:79], v[192:195]
    s_waitcnt lgkmcnt(13)
    v_add_f32 v140, v140, v160
    v_add_f32 v141, v141, v161
    v_mfma_f32_16x16x32_bf16 v[196:199], a[88:91], v[76:79], v[196:199]
    v_add_f32 v142, v142, v162
    v_add_f32 v143, v143, v163
    v_mfma_f32_16x16x32_bf16 v[196:199], a[108:111], v[80:83], v[196:199]
    s_waitcnt lgkmcnt(12)
    v_add_f32 v140, v140, v212
    v_add_f32 v141, v141, v213
    v_mfma_f32_16x16x32_bf16 v[200:203], a[112:115], v[80:83], v[200:203]
    v_add_f32 v142, v142, v214
    v_add_f32 v143, v143, v215
    v_mfma_f32_16x16x32_bf16 v[200:203], a[92:95], v[76:79], v[200:203]
    s_waitcnt lgkmcnt(10)
    v_add_f32 v144, v144, v164
    v_add_f32 v145, v145, v165
    v_mfma_f32_16x16x32_bf16 v[232:235], a[96:99], v[76:79], v[232:235]
    v_add_f32 v146, v146, v166
    v_add_f32 v147, v147, v167
    v_mfma_f32_16x16x32_bf16 v[232:235], a[116:119], v[80:83], v[232:235]
    s_waitcnt vmcnt(2)
    s_waitcnt lgkmcnt(9)
    v_add_f32 v144, v144, v216
    v_mfma_f32_16x16x32_bf16 v[188:191], a[120:123], v[84:87], v[188:191]
    v_add_f32 v145, v145, v217
    v_add_f32 v146, v146, v218
    v_mfma_f32_16x16x32_bf16 v[188:191], a[140:143], v[88:91], v[188:191]
    s_waitcnt vmcnt(0)
    v_add_f32 v147, v147, v219
    v_mfma_f32_16x16x32_bf16 v[188:191], a[160:163], v[92:95], v[188:191]
    s_waitcnt lgkmcnt(7)
    v_add_f32 v148, v148, v168
    v_add_f32 v149, v149, v169
    v_mfma_f32_16x16x32_bf16 v[188:191], a[180:183], v[96:99], v[188:191]
    v_add_f32 v150, v150, v170
    v_add_f32 v151, v151, v171
    v_mfma_f32_16x16x32_bf16 v[192:195], a[184:187], v[96:99], v[192:195]
    s_waitcnt lgkmcnt(6)
    v_add_f32 v148, v148, v220
    v_add_f32 v149, v149, v221
    v_mfma_f32_16x16x32_bf16 v[192:195], a[164:167], v[92:95], v[192:195]
    v_add_f32 v150, v150, v222
    v_add_f32 v151, v151, v223
    v_mfma_f32_16x16x32_bf16 v[192:195], a[144:147], v[88:91], v[192:195]
    v_mfma_f32_16x16x32_bf16 v[192:195], a[124:127], v[84:87], v[192:195]
    v_add_f32 v140, v140, v188
    v_add_f32 v141, v141, v189
    v_mfma_f32_16x16x32_bf16 v[196:199], a[128:131], v[84:87], v[196:199]
    v_add_f32 v142, v142, v190
    v_add_f32 v143, v143, v191
    v_mfma_f32_16x16x32_bf16 v[196:199], a[148:151], v[88:91], v[196:199]
    v_cvt_pk_bf16_f32 v172, v140, v141
    v_cvt_pk_bf16_f32 v173, v142, v143
    v_mfma_f32_16x16x32_bf16 v[196:199], a[168:171], v[92:95], v[196:199]
    v_mfma_f32_16x16x32_bf16 v[196:199], a[188:191], v[96:99], v[196:199]
    v_add_f32 v144, v144, v192
    v_add_f32 v145, v145, v193
    v_mfma_f32_16x16x32_bf16 v[200:203], a[192:195], v[96:99], v[200:203]
    v_add_f32 v146, v146, v194
    v_add_f32 v147, v147, v195
    v_mfma_f32_16x16x32_bf16 v[200:203], a[172:175], v[92:95], v[200:203]
    v_cvt_pk_bf16_f32 v174, v144, v145
    v_cvt_pk_bf16_f32 v175, v146, v147
    v_mfma_f32_16x16x32_bf16 v[200:203], a[152:155], v[88:91], v[200:203]
    ds_write_b128 v6, v[172:175] offset:0
    v_mfma_f32_16x16x32_bf16 v[200:203], a[132:135], v[84:87], v[200:203]
    s_waitcnt lgkmcnt(5)
    v_add_f32 v152, v152, v204
    v_add_f32 v153, v153, v205
    v_mfma_f32_16x16x32_bf16 v[232:235], a[136:139], v[84:87], v[232:235]
    v_add_f32 v154, v154, v206
    v_add_f32 v155, v155, v207
    v_mfma_f32_16x16x32_bf16 v[232:235], a[156:159], v[88:91], v[232:235]
    s_waitcnt lgkmcnt(4)
    v_add_f32 v152, v152, v224
    v_add_f32 v153, v153, v225
    v_mfma_f32_16x16x32_bf16 v[232:235], a[176:179], v[92:95], v[232:235]
    v_add_f32 v154, v154, v226
    v_add_f32 v155, v155, v227
    v_mfma_f32_16x16x32_bf16 v[232:235], a[196:199], v[96:99], v[232:235]
    v_pk_add_f32 v[148:149], v[148:149], v[196:197]
    v_pk_add_f32 v[150:151], v[150:151], v[198:199]
    v_cvt_pk_bf16_f32 v176, v148, v149
    v_cvt_pk_bf16_f32 v177, v150, v151
    s_waitcnt lgkmcnt(1)
    v_pk_add_f32 v[156:157], v[156:157], v[208:209]
    v_pk_add_f32 v[158:159], v[158:159], v[210:211]
    v_pk_add_f32 v[156:157], v[156:157], v[228:229]
    v_pk_add_f32 v[158:159], v[158:159], v[230:231]
    v_pk_add_f32 v[152:153], v[152:153], v[200:201]
    v_pk_add_f32 v[154:155], v[154:155], v[202:203]
    v_cvt_pk_bf16_f32 v178, v152, v153
    v_cvt_pk_bf16_f32 v179, v154, v155
    ds_write_b128 v6, v[176:179] offset:64
    v_pk_add_f32 v[156:157], v[156:157], v[232:233]
    v_pk_add_f32 v[158:159], v[158:159], v[234:235]
    v_cvt_pk_bf16_f32 v180, v156, v157
    v_cvt_pk_bf16_f32 v181, v158, v159
    ds_write_b64 v7, v[180:181] offset:128
    s_mov_b32 exec_hi, 0x0fffffff
    ds_read_b128 v[160:163], v238 offset:0
    ds_read_b128 v[164:167], v238 offset:1056
    ds_read_b128 v[168:171], v238 offset:2112
    s_waitcnt lgkmcnt(2)
    buffer_store_dwordx4 v[160:163], v237, s[48:51], s28 offen
    s_waitcnt lgkmcnt(1)
    buffer_store_dwordx4 v[164:167], v237, s[48:51], s34 offen
    s_mov_b32 exec_hi, 0xff
    s_waitcnt lgkmcnt(0)
    buffer_store_dwordx4 v[168:171], v237, s[48:51], s35 offen
    s_mov_b64 exec, -1
L_end:
L_exit:
    s_endpgm
L_go_c_slow:
    s_mov_b32 s32, 100000
L_go_c_spin:
    buffer_load_dword v123, v122, s[52:55], 0 offen sc1
    s_waitcnt vmcnt(0)
    v_cmp_gt_u32 vcc, 1, v123
    s_nop 0
    s_cbranch_vccz L_go_c_ok
    s_sub_u32 s32, s32, 1
    s_cbranch_scc0 L_go_c_spin
    s_branch L_go_c_ok
L_s1_slow:
    s_mov_b32 s32, 100000
L_s1_spin:
    buffer_load_dword v9, v8, s[8:11], s36 offen sc1
    s_waitcnt vmcnt(0)
    v_cmp_gt_u32 vcc, 1, v9
    s_nop 0
    s_cbranch_vccz L_s1_ok
    s_sub_u32 s32, s32, 1
    s_cbranch_scc0 L_s1_spin
    s_branch L_s1_ok
L_fa_slow:
    s_mov_b32 s32, 100000
L_fa_spin:
    buffer_load_dword v139, v138, s[8:11], s47 offen sc1
    s_waitcnt vmcnt(0)
    v_cmp_gt_u32 vcc, 1, v139
    s_nop 0
    s_cbranch_vccz L_fa_ok
    s_sub_u32 s32, s32, 1
    s_cbranch_scc0 L_fa_spin
    s_branch L_fa_ok
L_fd_c_slow:
    s_mov_b32 s32, 100000
L_fd_c_spin:
    buffer_load_dword v129, v128, s[8:11], s58 offen sc1
    s_waitcnt vmcnt(0)
    v_cmp_gt_u32 vcc, 1, v129
    s_nop 0
    s_cbranch_vccz L_fd_c_ok
    s_sub_u32 s32, s32, 1
    s_cbranch_scc0 L_fd_c_spin
    s_branch L_fd_c_ok
L_fw_c_slow:
    s_mov_b32 s32, 100000
L_fw_c_spin:
    buffer_load_dword v141, v140, s[8:11], s57 offen sc1
    s_waitcnt vmcnt(0)
    v_cmp_gt_u32 vcc, 1, v141
    s_nop 0
    s_cbranch_vccz L_fw_c_ok
    s_cmp_lg_u32 s32, 100000
    s_cbranch_scc1 L_fw_c_again
    buffer_store_dword v253, v252, s[8:11], s41 offen sc1
L_fw_c_again:
    s_sub_u32 s32, s32, 1
    s_cbranch_scc0 L_fw_c_spin
    s_branch L_fw_c_ok
L_go_a_slow:
    s_mov_b32 s32, 100000
L_go_a_spin:
    buffer_load_dword v123, v122, s[52:55], 0 offen sc1
    s_waitcnt vmcnt(0)
    v_cmp_gt_u32 vcc, 1, v123
    s_nop 0
    s_cbranch_vccz L_go_a_ok
    s_sub_u32 s32, s32, 1
    s_cbranch_scc0 L_go_a_spin
    s_branch L_go_a_ok
L_go_b_slow:
    s_mov_b32 s32, 100000
L_go_b_spin:
    buffer_load_dword v123, v122, s[52:55], 0 offen sc1
    s_waitcnt vmcnt(0)
    v_cmp_gt_u32 vcc, 1, v123
    s_nop 0
    s_cbranch_vccz L_go_b_ok
    s_sub_u32 s32, s32, 1
    s_cbranch_scc0 L_go_b_spin
    s_branch L_go_b_ok
L_can_slow:
    s_mov_b32 s32, 100000
L_can_spin:
    buffer_load_dword v11, v15, s[8:11], s46 offen sc1
    s_waitcnt vmcnt(0)
    v_cmp_gt_u32 vcc, 1, v11
    s_nop 0
    s_cbranch_vccz L_can_ok
    s_sub_u32 s32, s32, 1
    s_cbranch_scc0 L_can_spin
    s_branch L_can_ok
L_fx2_slow:
    s_mov_b32 s32, 100000
L_fx2_spin:
    buffer_load_dword v14, v13, s[8:11], s47 offen sc1
    s_waitcnt vmcnt(0)
    v_cmp_gt_u32 vcc, 1, v14
    s_nop 0
    s_cbranch_vccz L_fx2_ok
    s_sub_u32 s32, s32, 1
    s_cbranch_scc0 L_fx2_spin
    s_branch L_fx2_ok
L_fd_s_slow:
    s_mov_b32 s32, 100000
L_fd_s_spin:
    buffer_load_dword v11, v10, s[8:11], s58 offen sc1
    s_waitcnt vmcnt(0)
    v_cmp_gt_u32 vcc, 1, v11
    s_nop 0
    s_cbranch_vccz L_fd_s_ok
    s_sub_u32 s32, s32, 1
    s_cbranch_scc0 L_fd_s_spin
    s_branch L_fd_s_ok
L_fx_s_slow:
    s_mov_b32 s32, 100000
L_fx_s_spin:
    buffer_load_dword v14, v13, s[8:11], s47 offen sc1
    s_waitcnt vmcnt(0)
    v_cmp_gt_u32 vcc, 1, v14
    s_nop 0
    s_cbranch_vccz L_fx_s_ok
    s_sub_u32 s32, s32, 1
    s_cbranch_scc0 L_fx_s_spin
    s_branch L_fx_s_ok
L_can2_slow:
    s_mov_b32 s32, 100000
L_can2_spin:
    buffer_load_dword v11, v15, s[8:11], s46 offen sc1
    s_waitcnt vmcnt(0)
    v_cmp_gt_u32 vcc, 1, v11
    s_nop 0
    s_cbranch_vccz L_can2_ok
    s_sub_u32 s32, s32, 1
    s_cbranch_scc0 L_can2_spin
    s_branch L_can2_ok
L_fw_s_slow:
    s_mov_b32 s32, 100000
L_fw_s_spin:
    buffer_load_dword v9, v8, s[8:11], s57 offen sc1
    s_waitcnt vmcnt(0)
    v_cmp_gt_u32 vcc, 1, v9
    s_nop 0
    s_cbranch_vccz L_fw_s_ok
    s_sub_u32 s32, s32, 1
    s_cbranch_scc0 L_fw_s_spin
    s_branch L_fw_s_ok
L_s2_slow:
    s_mov_b32 s32, 100000
L_s2_spin:
    buffer_load_dword v11, v142, s[8:11], s14 offen sc1
    s_waitcnt vmcnt(0)
    v_cmp_gt_u32 vcc, 1, v11
    s_nop 0
    s_cbranch_vccz L_s2_ok
    s_cmp_lg_u32 s32, 100000
    s_cbranch_scc1 L_s2_again
    buffer_store_dword v253, v252, s[8:11], s41 offen sc1
L_s2_again:
    s_sub_u32 s32, s32, 1
    s_cbranch_scc0 L_s2_spin
    s_branch L_s2_ok
L_hspin_slow:
    s_mov_b32 s32, 100000
L_hspin_spin:
    buffer_load_dword v231, v228, s[8:11], s29 offen sc1
    buffer_load_dword v232, v229, s[8:11], s29 offen sc1
    buffer_load_dword v233, v230, s[8:11], s29 offen sc1
    s_waitcnt vmcnt(0)
    v_min3_u32 v231, v231, v232, v233
    v_cmp_gt_u32 vcc, 1, v231
    s_nop 0
    s_cbranch_vccz L_hspin_ok
    s_sub_u32 s32, s32, 1
    s_cbranch_scc0 L_hspin_spin
    s_branch L_hspin_ok
L_hv0:
    s_cmp_eq_u32 s15, 1
    s_cbranch_scc1 L_hok0
    s_movk_i32 s14, 0
    s_sub_u32 s13, s13, 1
    s_cbranch_scc1 L_hwait
L_hl0:
    s_add_u32 s12, s3, 0
    buffer_load_dwordx4 v[8:11], v6, s[8:11], s12 offen offset:0 sc1
    buffer_load_dwordx4 v[12:15], v6, s[8:11], s12 offen offset:256 sc1
    buffer_load_dwordx4 v[16:19], v6, s[8:11], s12 offen offset:2048 sc1
    buffer_load_dwordx4 v[20:23], v6, s[8:11], s12 offen offset:2304 sc1
    s_waitcnt vmcnt(0)
    v_swap_b32 v10, v12
    v_swap_b32 v11, v13
    v_swap_b32 v18, v20
    v_swap_b32 v19, v21
    v_mfma_f32_16x16x32_bf16 v[204:207], v[8:11], v[8:11], 0
    s_nop 0
    v_mfma_f32_16x16x32_bf16 v[204:207], v[16:19], v[16:19], v[204:207]
    v_mfma_f32_16x16x32_bf16 v[208:211], v[12:15], v[12:15], 0
    v_mfma_f32_16x16x32_bf16 v[208:211], v[20:23], v[20:23], v[208:211]
    s_nop 7
    v_cmp_u_f32 vcc, v204, v208
    s_cmp_eq_u32 s15, 2
    s_cbranch_scc1 L_hok0
    s_cbranch_vccnz L_hv0
    s_branch L_hok0
L_hv1:
    s_cmp_eq_u32 s15, 1
    s_cbranch_scc1 L_hok1
    s_movk_i32 s14, 1
    s_sub_u32 s13, s13, 1
    s_cbranch_scc1 L_hwait
L_hl1:
    s_add_u32 s12, s3, 4096
    buffer_load_dwordx4 v[24:27], v6, s[8:11], s12 offen offset:0 sc1
    buffer_load_dwordx4 v[28:31], v6, s[8:11], s12 offen offset:256 sc1
    buffer_load_dwordx4 v[32:35], v6, s[8:11], s12 offen offset:2048 sc1
    buffer_load_dwordx4 v[36:39], v6, s[8:11], s12 offen offset:2304 sc1
    s_waitcnt vmcnt(0)
    v_swap_b32 v26, v28
    v_swap_b32 v27, v29
    v_swap_b32 v34, v36
    v_swap_b32 v35, v37
    v_mfma_f32_16x16x32_bf16 v[212:215], v[24:27], v[24:27], v[204:207]
    s_nop 0
    v_mfma_f32_16x16x32_bf16 v[212:215], v[32:35], v[32:35], v[212:215]
    v_mfma_f32_16x16x32_bf16 v[216:219], v[28:31], v[28:31], v[208:211]
    v_mfma_f32_16x16x32_bf16 v[216:219], v[36:39], v[36:39], v[216:219]
    s_nop 7
    v_cmp_u_f32 vcc, v212, v216
    s_cmp_eq_u32 s15, 2
    s_cbranch_scc1 L_hok1
    s_cbranch_vccnz L_hv1
    s_branch L_hok1
L_hv2:
    s_cmp_eq_u32 s15, 1
    s_cbranch_scc1 L_hok2
    s_movk_i32 s14, 2
    s_sub_u32 s13, s13, 1
    s_cbranch_scc1 L_hwait
L_hl2:
    s_add_u32 s12, s3, 8192
    buffer_load_dwordx4 v[40:43], v6, s[8:11], s12 offen offset:0 sc1
    buffer_load_dwordx4 v[44:47], v6, s[8:11], s12 offen offset:256 sc1
    buffer_load_dwordx4 v[48:51], v6, s[8:11], s12 offen offset:2048 sc1
    buffer_load_dwordx4 v[52:55], v6, s[8:11], s12 offen offset:2304 sc1
    s_waitcnt vmcnt(0)
    v_swap_b32 v42, v44
    v_swap_b32 v43, v45
    v_swap_b32 v50, v52
    v_swap_b32 v51, v53
    v_mfma_f32_16x16x32_bf16 v[204:207], v[40:43], v[40:43], v[212:215]
    s_nop 0
    v_mfma_f32_16x16x32_bf16 v[204:207], v[48:51], v[48:51], v[204:207]
    v_mfma_f32_16x16x32_bf16 v[208:211], v[44:47], v[44:47], v[216:219]
    v_mfma_f32_16x16x32_bf16 v[208:211], v[52:55], v[52:55], v[208:211]
    s_nop 7
    v_cmp_u_f32 vcc, v204, v208
    s_cmp_eq_u32 s15, 2
    s_cbranch_scc1 L_hok2
    s_cbranch_vccnz L_hv2
    s_branch L_hok2
L_hv3:
    s_cmp_eq_u32 s15, 1
    s_cbranch_scc1 L_hok3
    s_movk_i32 s14, 3
    s_sub_u32 s13, s13, 1
    s_cbranch_scc1 L_hwait
L_hl3:
    s_add_u32 s12, s3, 12288
    buffer_load_dwordx4 v[56:59], v6, s[8:11], s12 offen offset:0 sc1
    buffer_load_dwordx4 v[60:63], v6, s[8:11], s12 offen offset:256 sc1
    buffer_load_dwordx4 v[64:67], v6, s[8:11], s12 offen offset:2048 sc1
    buffer_load_dwordx4 v[68:71], v6, s[8:11], s12 offen offset:2304 sc1
    s_waitcnt vmcnt(0)
    v_swap_b32 v58, v60
    v_swap_b32 v59, v61
    v_swap_b32 v66, v68
    v_swap_b32 v67, v69
    v_mfma_f32_16x16x32_bf16 v[212:215], v[56:59], v[56:59], v[204:207]
    s_nop 0
    v_mfma_f32_16x16x32_bf16 v[212:215], v[64:67], v[64:67], v[212:215]
    v_mfma_f32_16x16x32_bf16 v[216:219], v[60:63], v[60:63], v[208:211]
    v_mfma_f32_16x16x32_bf16 v[216:219], v[68:71], v[68:71], v[216:219]
    s_nop 7
    v_cmp_u_f32 vcc, v212, v216
    s_cmp_eq_u32 s15, 2
    s_cbranch_scc1 L_hok3
    s_cbranch_vccnz L_hv3
    s_branch L_hok3
L_hv4:
    s_cmp_eq_u32 s15, 1
    s_cbranch_scc1 L_hok4
    s_movk_i32 s14, 4
    s_sub_u32 s13, s13, 1
    s_cbranch_scc1 L_hwait
L_hl4:
    s_add_u32 s12, s3, 16384
    buffer_load_dwordx4 v[72:75], v6, s[8:11], s12 offen offset:0 sc1
    buffer_load_dwordx4 v[76:79], v6, s[8:11], s12 offen offset:256 sc1
    buffer_load_dwordx4 v[80:83], v6, s[8:11], s12 offen offset:2048 sc1
    buffer_load_dwordx4 v[84:87], v6, s[8:11], s12 offen offset:2304 sc1
    s_waitcnt vmcnt(0)
    v_swap_b32 v74, v76
    v_swap_b32 v75, v77
    v_swap_b32 v82, v84
    v_swap_b32 v83, v85
    v_mfma_f32_16x16x32_bf16 v[204:207], v[72:75], v[72:75], v[212:215]
    s_nop 0
    v_mfma_f32_16x16x32_bf16 v[204:207], v[80:83], v[80:83], v[204:207]
    v_mfma_f32_16x16x32_bf16 v[208:211], v[76:79], v[76:79], v[216:219]
    v_mfma_f32_16x16x32_bf16 v[208:211], v[84:87], v[84:87], v[208:211]
    s_nop 7
    v_cmp_u_f32 vcc, v204, v208
    s_cmp_eq_u32 s15, 2
    s_cbranch_scc1 L_hok4
    s_cbranch_vccnz L_hv4
    s_branch L_hok4
L_hv5:
    s_cmp_eq_u32 s15, 1
    s_cbranch_scc1 L_hok5
    s_movk_i32 s14, 5
    s_sub_u32 s13, s13, 1
    s_cbranch_scc1 L_hwait
L_hl5:
    s_add_u32 s12, s3, 20480
    buffer_load_dwordx4 v[88:91], v6, s[8:11], s12 offen offset:0 sc1
    buffer_load_dwordx4 v[92:95], v6, s[8:11], s12 offen offset:256 sc1
    buffer_load_dwordx4 v[96:99], v6, s[8:11], s12 offen offset:2048 sc1
    buffer_load_dwordx4 v[100:103], v6, s[8:11], s12 offen offset:2304 sc1
    s_waitcnt vmcnt(0)
    v_swap_b32 v90, v92
    v_swap_b32 v91, v93
    v_swap_b32 v98, v100
    v_swap_b32 v99, v101
    v_mfma_f32_16x16x32_bf16 v[212:215], v[88:91], v[88:91], v[204:207]
    s_nop 0
    v_mfma_f32_16x16x32_bf16 v[212:215], v[96:99], v[96:99], v[212:215]
    v_mfma_f32_16x16x32_bf16 v[216:219], v[92:95], v[92:95], v[208:211]
    v_mfma_f32_16x16x32_bf16 v[216:219], v[100:103], v[100:103], v[216:219]
    s_nop 7
    v_cmp_u_f32 vcc, v212, v216
    s_cmp_eq_u32 s15, 2
    s_cbranch_scc1 L_hok5
    s_cbranch_vccnz L_hv5
    s_branch L_hok5
L_hv6:
    s_cmp_eq_u32 s15, 1
    s_cbranch_scc1 L_hok6
    s_movk_i32 s14, 6
    s_sub_u32 s13, s13, 1
    s_cbranch_scc1 L_hwait
L_hl6:
    s_add_u32 s12, s3, 24576
    buffer_load_dwordx4 v[104:107], v6, s[8:11], s12 offen offset:0 sc1
    buffer_load_dwordx4 v[108:111], v6, s[8:11], s12 offen offset:256 sc1
    buffer_load_dwordx4 v[112:115], v6, s[8:11], s12 offen offset:2048 sc1
    buffer_load_dwordx4 v[116:119], v6, s[8:11], s12 offen offset:2304 sc1
    s_waitcnt vmcnt(0)
    v_swap_b32 v106, v108
    v_swap_b32 v107, v109
    v_swap_b32 v114, v116
    v_swap_b32 v115, v117
    v_mfma_f32_16x16x32_bf16 v[204:207], v[104:107], v[104:107], v[212:215]
    s_nop 0
    v_mfma_f32_16x16x32_bf16 v[204:207], v[112:115], v[112:115], v[204:207]
    v_mfma_f32_16x16x32_bf16 v[208:211], v[108:111], v[108:111], v[216:219]
    v_mfma_f32_16x16x32_bf16 v[208:211], v[116:119], v[116:119], v[208:211]
    s_nop 7
    v_cmp_u_f32 vcc, v204, v208
    s_cmp_eq_u32 s15, 2
    s_cbranch_scc1 L_hok6
    s_cbranch_vccnz L_hv6
    s_branch L_hok6
L_hv7:
    s_cmp_eq_u32 s15, 1
    s_cbranch_scc1 L_hok7
    s_movk_i32 s14, 7
    s_sub_u32 s13, s13, 1
    s_cbranch_scc1 L_hwait
L_hl7:
    s_add_u32 s12, s3, 28672
    buffer_load_dwordx4 v[120:123], v6, s[8:11], s12 offen offset:0 sc1
    buffer_load_dwordx4 v[124:127], v6, s[8:11], s12 offen offset:256 sc1
    buffer_load_dwordx4 v[128:131], v6, s[8:11], s12 offen offset:2048 sc1
    buffer_load_dwordx4 v[132:135], v6, s[8:11], s12 offen offset:2304 sc1
    s_waitcnt vmcnt(0)
    v_swap_b32 v122, v124
    v_swap_b32 v123, v125
    v_swap_b32 v130, v132
    v_swap_b32 v131, v133
    v_mfma_f32_16x16x32_bf16 v[212:215], v[120:123], v[120:123], v[204:207]
    s_nop 0
    v_mfma_f32_16x16x32_bf16 v[212:215], v[128:131], v[128:131], v[212:215]
    v_mfma_f32_16x16x32_bf16 v[216:219], v[124:127], v[124:127], v[208:211]
    v_mfma_f32_16x16x32_bf16 v[216:219], v[132:135], v[132:135], v[216:219]
    s_nop 7
    v_cmp_u_f32 vcc, v212, v216
    s_cmp_eq_u32 s15, 2
    s_cbranch_scc1 L_hok7
    s_cbranch_vccnz L_hv7
    s_branch L_hok7
L_hv8:
    s_cmp_eq_u32 s15, 1
    s_cbranch_scc1 L_hok8
    s_movk_i32 s14, 8
    s_sub_u32 s13, s13, 1
    s_cbranch_scc1 L_hwait
L_hl8:
    s_add_u32 s12, s3, 32768
    buffer_load_dwordx4 v[136:139], v6, s[8:11], s12 offen offset:0 sc1
    buffer_load_dwordx4 v[140:143], v6, s[8:11], s12 offen offset:256 sc1
    buffer_load_dwordx4 v[144:147], v6, s[8:11], s12 offen offset:2048 sc1
    buffer_load_dwordx4 v[148:151], v6, s[8:11], s12 offen offset:2304 sc1
    s_waitcnt vmcnt(0)
    v_swap_b32 v138, v140
    v_swap_b32 v139, v141
    v_swap_b32 v146, v148
    v_swap_b32 v147, v149
    v_mfma_f32_16x16x32_bf16 v[204:207], v[136:139], v[136:139], v[212:215]
    s_nop 0
    v_mfma_f32_16x16x32_bf16 v[204:207], v[144:147], v[144:147], v[204:207]
    v_mfma_f32_16x16x32_bf16 v[208:211], v[140:143], v[140:143], v[216:219]
    v_mfma_f32_16x16x32_bf16 v[208:211], v[148:151], v[148:151], v[208:211]
    s_nop 7
    v_cmp_u_f32 vcc, v204, v208
    s_cmp_eq_u32 s15, 2
    s_cbranch_scc1 L_hok8
    s_cbranch_vccnz L_hv8
    s_branch L_hok8
L_hv9:
    s_cmp_eq_u32 s15, 1
    s_cbranch_scc1 L_hok9
    s_movk_i32 s14, 9
    s_sub_u32 s13, s13, 1
    s_cbranch_scc1 L_hwait
L_hl9:
    s_add_u32 s12, s3, 36864
    buffer_load_dwordx4 v[152:155], v6, s[8:11], s12 offen offset:0 sc1
    buffer_load_dwordx4 v[156:159], v6, s[8:11], s12 offen offset:256 sc1
    buffer_load_dwordx4 v[160:163], v6, s[8:11], s12 offen offset:2048 sc1
    buffer_load_dwordx4 v[164:167], v6, s[8:11], s12 offen offset:2304 sc1
    s_waitcnt vmcnt(0)
    v_swap_b32 v154, v156
    v_swap_b32 v155, v157
    v_swap_b32 v162, v164
    v_swap_b32 v163, v165
    v_mfma_f32_16x16x32_bf16 v[212:215], v[152:155], v[152:155], v[204:207]
    s_nop 0
    v_mfma_f32_16x16x32_bf16 v[212:215], v[160:163], v[160:163], v[212:215]
    v_mfma_f32_16x16x32_bf16 v[216:219], v[156:159], v[156:159], v[208:211]
    v_mfma_f32_16x16x32_bf16 v[216:219], v[164:167], v[164:167], v[216:219]
    s_nop 7
    v_cmp_u_f32 vcc, v212, v216
    s_cmp_eq_u32 s15, 2
    s_cbranch_scc1 L_hok9
    s_cbranch_vccnz L_hv9
    s_branch L_hok9
L_hwait:
    v_mul_u32_u24 v228, 128, v0
    v_add_u32 v229, 8192, v228
    v_add_u32 v230, 12288, v228
    s_branch L_hspin_slow
L_hspin_ok:
    s_mov_b32 s15, 2
    s_cmp_eq_u32 s14, 0
    s_cbranch_scc1 L_hl0
    s_cmp_eq_u32 s14, 1
    s_cbranch_scc1 L_hl1
    s_cmp_eq_u32 s14, 2
    s_cbranch_scc1 L_hl2
    s_cmp_eq_u32 s14, 3
    s_cbranch_scc1 L_hl3
    s_cmp_eq_u32 s14, 4
    s_cbranch_scc1 L_hl4
    s_cmp_eq_u32 s14, 5
    s_cbranch_scc1 L_hl5
    s_cmp_eq_u32 s14, 6
    s_cbranch_scc1 L_hl6
    s_cmp_eq_u32 s14, 7
    s_cbranch_scc1 L_hl7
    s_cmp_eq_u32 s14, 8
    s_cbranch_scc1 L_hl8
    s_branch L_hl9
L_scp1_slow:
    s_mov_b32 s32, 100000
L_scp1_spin:
    buffer_load_dword v255, v254, s[8:11], s19 offen sc1
    s_waitcnt vmcnt(0)
    v_cmp_gt_u32 vcc, 1, v255
    s_nop 0
    s_cbranch_vccz L_scp1_ok
    s_sub_u32 s32, s32, 1
    s_cbranch_scc0 L_scp1_spin
    s_branch L_scp1_ok
L_scp2_slow:
    s_mov_b32 s32, 100000
L_scp2_spin:
    buffer_load_dword v255, v254, s[8:11], s19 offen sc1
    s_waitcnt vmcnt(0)
    v_cmp_gt_u32 vcc, 1, v255
    s_nop 0
    s_cbranch_vccz L_scp2_ok
    s_sub_u32 s32, s32, 1
    s_cbranch_scc0 L_scp2_spin
    s_branch L_scp2_ok
L_scp3_slow:
    s_mov_b32 s32, 100000
L_scp3_spin:
    buffer_load_dword v255, v254, s[8:11], s19 offen sc1
    s_waitcnt vmcnt(0)
    v_cmp_gt_u32 vcc, 1, v255
    s_nop 0
    s_cbranch_vccz L_scp3_ok
    s_sub_u32 s32, s32, 1
    s_cbranch_scc0 L_scp3_spin
    s_branch L_scp3_ok
L_scp4_slow:
    s_mov_b32 s32, 100000
L_scp4_spin:
    buffer_load_dword v255, v254, s[8:11], s20 offen sc1
    s_waitcnt vmcnt(0)
    v_cmp_gt_u32 vcc, 1, v255
    s_nop 0
    s_cbranch_vccz L_scp4_ok
    s_sub_u32 s32, s32, 1
    s_cbranch_scc0 L_scp4_spin
    s_branch L_scp4_ok
L_code_end:
.section .rodata,"a"
.p2align 6
.amdhsa_kernel sequential_preLN__ssm_conv_h3__glu_gated_glu__prompt_kernel
  .amdhsa_next_free_vgpr 512
  .amdhsa_next_free_sgpr 102
  .amdhsa_accum_offset 256
  .amdhsa_group_segment_fixed_size 0
  .amdhsa_kernarg_size 104
  .amdhsa_user_sgpr_count 2
  .amdhsa_user_sgpr_kernarg_segment_ptr 1
  .amdhsa_system_sgpr_workgroup_id_x 1
  .amdhsa_float_denorm_mode_32 3
.end_amdhsa_kernel
```
